```python
import torch

def _softmax(x, axis=-1):
    return torch.softmax(x, dim=axis)
def _gelu(x):
    return torch.nn.functional.gelu(x, approximate="tanh")
def _silu(x):
    return torch.nn.functional.silu(x)
def _sigmoid(x):
    return torch.sigmoid(x)
def _layernorm(x, axis=-1, eps=1e-5):
    m = x.mean(dim=axis, keepdim=True)
    v = x.var(dim=axis, keepdim=True, unbiased=False)
    return (x - m) / torch.sqrt(v + eps)
def _scatter_add(tgt, idx, src, axis=0):
    return tgt.clone().index_add_(axis, idx, src)
def _segment_sum(src, seg, n):
    out = torch.zeros((n,) + src.shape[1:], dtype=src.dtype)
    return out.index_add_(0, seg, src)
def _pad(x, pw):
    flat = tuple(v for pair in reversed(pw) for v in pair)
    return torch.nn.functional.pad(x, flat)

kernel_name = 'gated_mix__sliding_local_dilated__dense_activation_mish__prompt'

def setup_inputs():

    _w = (lambda a: (lambda t: t.to(torch.bfloat16) if t.is_floating_point() else t)(torch.as_tensor(a)))
    def _A_setup():
        B, S, D = 1, 2048, 512
        return {
            "x": _w((lambda *s: torch.randn(*s, dtype=torch.bfloat16) * 0.05)(B, S, D)),
            "wqkv": _w((lambda *s: torch.randn(*s, dtype=torch.bfloat16) * 0.8)(D, 3 * D)),
            "wo": _w((lambda *s: torch.randn(*s, dtype=torch.bfloat16) * 0.05)(D, D)),
        }
    _A_in = _A_setup()

    def _B_setup():
        B, S, D, F = 1, 2048, 512, 1376
        return {
            "x": _w((lambda *s: torch.randn(*s, dtype=torch.bfloat16) * 0.05)(B, S, D)),
            "w1": _w((lambda *s: torch.randn(*s, dtype=torch.bfloat16) * 12.8)(D, F) * (D ** -0.5)),
            "b1": _w((lambda *s: torch.randn(*s, dtype=torch.bfloat16) * 0.8)(F)),
            "w2": _w((lambda *s: torch.randn(*s, dtype=torch.bfloat16) * 0.8)(F, D) * (F ** -0.5)),
        }
    _B_in = _B_setup()

    return {
        "A_x": _A_in["x"],
        "A_wqkv": _A_in["wqkv"],
        "A_wo": _A_in["wo"],
        "B_x": _B_in["x"],
        "B_w1": _B_in["w1"],
        "B_b1": _B_in["b1"],
        "B_w2": _B_in["w2"],
        "gate_w": _w((lambda *s: torch.randn(*s, dtype=torch.bfloat16) * 0.05)(512) * 16.0),
    }

def reference(A_x, A_wqkv, A_wo, B_x, B_w1, B_b1, B_w2, gate_w):
    def _A_ref(x, wqkv, wo):
        B, S, D = x.shape
        H = 32; Dh = D // H
        W, dil = 8, 2
        qkv = (lambda x, *d: x.permute(*d))((x @ wqkv).reshape(B, S, 3, H, Dh), 2, 0, 3, 1, 4)
        q, k, v = qkv[0], qkv[1], qkv[2]
        scale = Dh ** -0.5
        pos = torch.arange(S)
        off = torch.arange(W) * dil
        idx = pos[:, None] - off[None, :]
        mask = idx >= 0
        idx_c = torch.where(mask, idx, 0).reshape(-1)
        kg = k[:, :, idx_c, :].reshape(B, H, S, W, Dh)
        vg = v[:, :, idx_c, :].reshape(B, H, S, W, Dh)
        logits = torch.einsum("bhsd,bhswd->bhsw", q, kg) * scale
        logits = torch.where(mask[None, None, :, :], logits, -1e9)
        attn = _softmax(logits, axis=-1)
        o = torch.einsum("bhsw,bhswd->bhsd", attn, vg)
        return (lambda x, *d: x.permute(*d))(o, 0, 2, 1, 3).reshape(B, S, D) @ wo

    def _B_ref(x, w1, b1, w2):
        h = torch.einsum("bsd,df->bsf", x, w1) + b1
        sp = torch.log1p(torch.exp(-torch.abs(h))) + torch.where(h > 0, h, torch.zeros_like(h))
        act = h * torch.tanh(sp)
        return torch.einsum("bsf,fd->bsd", act, w2)

    x = A_x
    g = _sigmoid((x * gate_w).sum(-1, keepdims=True))
    a = _A_ref(x, A_wqkv, A_wo)
    b = _B_ref(x, B_w1, B_b1, B_w2)
    return g * a + (1 - g) * b
```

```asm
; @launch grid=(256,1,1) block=(512,1,1) lds=163840
.amdgcn_target "amdgcn-amd-amdhsa--gfx950"
.text
.globl gated_mix__sliding_local_dilated__dense_activation_mish__prompt_kernel
.p2align 8
.type gated_mix__sliding_local_dilated__dense_activation_mish__prompt_kernel,@function
gated_mix__sliding_local_dilated__dense_activation_mish__prompt_kernel:

L_fused_start:
    s_cmp_ge_u32 s2, 256
    s_cbranch_scc1 L_fused_end
    s_load_dwordx16 s[64:79], s[0:1], 0
    s_load_dwordx4 s[80:83], s[0:1], 64
    s_load_dwordx2 s[84:85], s[0:1], 80
    v_lshrrev_b32 v1, 6, v0
    v_and_b32 v2, 63, v0
    s_lshr_b32 s32, s2, 3
    v_readfirstlane_b32 s30, v1
    s_and_b32 s31, s2, 7
    s_lshr_b32 s38, 7, s30
    s_and_b32 s38, s38, 1
    s_cbranch_scc0 L_fused_noet1
    v_lshlrev_b32 v3, 7, v2
    s_waitcnt lgkmcnt(0)
    s_mov_b32 s38, 0x2000
    s_mov_b64 s[52:53], s[64:65]
    s_cmp_eq_u32 s30, 1
    s_cselect_b32 s38, 0x1800, s38
    s_cselect_b64 s[52:53], s[66:67], s[52:53]
    s_cmp_ge_u32 s30, 2
    s_cselect_b32 s38, 0x1580, s38
    s_cselect_b64 s[52:53], s[72:73], s[52:53]
    s_cmp_eq_u32 s30, 3
    s_cselect_b64 s[52:53], s[76:77], s[52:53]
    s_mul_i32 s39, s38, s2
    v_cmp_gt_u32 vcc, s38, v3
    v_add_u32 v3, s39, v3
    s_mov_b64 exec, vcc
    global_load_dword v19, v3, s[52:53]
    s_mov_b64 exec, -1
L_fused_noet1:
    s_and_b32 s33, s31, 1
    s_lshl_b32 s33, s33, 3
    s_and_b32 s41, s32, 7
    s_add_u32 s33, s33, s41
    s_lshr_b32 s34, s31, 1
    s_lshr_b32 s38, s32, 3
    s_lshl_b32 s39, s38, 2
    s_add_u32 s34, s34, s39
    s_lshl_b32 s40, s31, 2
    s_add_u32 s40, s40, s38
    s_lshr_b32 s35, s34, 3
    s_and_b32 s36, s30, 3
    s_lshr_b32 s37, s36, 1
    s_sub_u32 s3, 3, s36
    s_cmp_lt_u32 s30, 4
    s_cselect_b32 s3, s36, s3
    v_lshlrev_b32 v16, 4, v2
    s_cmp_lt_u32 s30, 4
    s_cbranch_scc1 L_fused_mfma
    v_lshrrev_b32 v3, 3, v2
    v_and_b32 v4, 7, v2
    s_cmp_eq_u32 s35, 0
    s_mov_b32 s51, 2752
    s_cselect_b32 s51, 3072, s51
    s_mov_b32 s43, 128
    s_cselect_b32 s43, 1024, s43
    s_mov_b32 s39, 384
    s_cselect_b32 s39, 128, s39
    s_lshl_b32 s44, s43, 1
    s_lshl_b32 s45, s51, 6
    s_and_b32 s38, s34, 7
    s_mul_i32 s53, s38, s39
    v_and_b32 v5, 2, v3
    v_xor_b32 v5, v5, v4
    s_and_b32 s38, s36, 1
    s_lshl_b32 s39, s38, 2
    v_xor_b32 v5, s39, v5
    v_lshlrev_b32 v5, 4, v5
    s_lshl_b32 s39, s36, 3
    v_add_u32 v6, s39, v3
    v_mad_u32_u24 v10, v6, s51, v5
    s_lshl_b32 s39, s38, 3
    v_add_u32 v6, s39, v3
    v_lshrrev_b32 v5, 1, v6
    v_xor_b32 v5, v5, v4
    v_and_b32 v5, 7, v5
    v_lshlrev_b32 v5, 4, v5
    v_lshl_add_u32 v11, v6, 10, v5
    s_lshl_b32 s47, s36, 10
    s_lshl_b32 s39, s33, 17
    s_sub_u32 s48, s39, 16384
    s_max_i32 s48, s48, 0
    s_lshl_b32 s49, s37, 14
    s_add_u32 s49, s49, s39
    s_lshl_b32 s50, s37, 11
    s_lshl_b32 s39, s38, 10
    s_add_u32 s50, s50, s39
    s_add_u32 s50, s50, 2048
    s_lshr_b32 s39, s32, 3
    s_lshl_b32 s39, s39, 1
    s_add_u32 s39, s39, s41
    s_and_b32 s39, s39, 7
    s_mov_b32 s52, 0
    s_or_b32 s39, s35, s37
    s_cmp_eq_u32 s39, 0
    s_cselect_b64 vcc, -1, 0
    s_waitcnt lgkmcnt(0)
    s_mov_b32 s4, s64
    s_mov_b32 s5, s65
    s_mov_b32 s6, 0x200000
    s_mov_b32 s7, 0x20000
    s_cmp_eq_u32 s35, 0
    s_cselect_b32 s8, s66, s72
    s_cselect_b32 s9, s67, s73
    s_mov_b32 s10, 0x158000
    s_cselect_b32 s10, 0x180000, s10
    s_mov_b32 s11, 0x20000
    s_add_u32 s38, s52, 0
    s_and_b32 s38, s38, 7
    s_mul_i32 s42, s38, s45
    s_add_u32 s42, s42, s53
    s_add_u32 m0, s47, 0
    s_mov_b32 s46, s42
    buffer_load_dwordx4 v10, s[8:11], s46 offen lds
    s_add_u32 m0, s47, 4096
    s_add_u32 s46, s42, s43
    buffer_load_dwordx4 v10, s[8:11], s46 offen lds
    s_add_u32 m0, s47, 8192
    s_add_u32 s46, s42, s44
    buffer_load_dwordx4 v10, s[8:11], s46 offen lds
    s_add_u32 s38, s52, 0
    s_and_b32 s38, s38, 7
    s_lshl_b32 s38, s38, 7
    s_add_u32 s54, s49, s38
    s_cbranch_vccz L_fused_nohalo2
    s_add_u32 m0, s50, 71680
    s_add_u32 s46, s48, s38
    buffer_load_dwordx4 v11, s[4:7], s46 offen lds
L_fused_nohalo2:
    s_add_u32 m0, s50, 73728
    s_add_u32 s46, s54, 0
    buffer_load_dwordx4 v11, s[4:7], s46 offen lds
    s_add_u32 m0, s50, 77824
    s_add_u32 s46, s54, 32768
    buffer_load_dwordx4 v11, s[4:7], s46 offen lds
    s_add_u32 m0, s50, 81920
    s_add_u32 s46, s54, 65536
    buffer_load_dwordx4 v11, s[4:7], s46 offen lds
    s_add_u32 m0, s50, 86016
    s_add_u32 s46, s54, 98304
    buffer_load_dwordx4 v11, s[4:7], s46 offen lds
    s_cmp_eq_u32 s3, 0
    s_cselect_b32 s12, s68, s76
    s_cselect_b32 s13, s69, s77
    s_mov_b32 s14, 0x158000
    s_cselect_b32 s14, 0x80000, s14
    s_mov_b32 s15, 0x20000
    s_mov_b32 s16, s84
    s_mov_b32 s17, s85
    s_mov_b32 s18, 0x800000
    s_mov_b32 s19, 0x20000
    s_mov_b32 s20, s80
    s_mov_b32 s21, s81
    s_mov_b32 s22, 0x200000
    s_mov_b32 s23, 0x20000
    s_mov_b32 s28, s82
    s_mov_b32 s29, s83
    s_mul_i32 s38, s36, 118
    v_add_u32 v13, s38, v2
    s_lshr_b32 s38, s45, 1
    s_add_u32 s42, s42, s38
    s_add_u32 m0, s47, 12288
    s_mov_b32 s46, s42
    buffer_load_dwordx4 v10, s[8:11], s46 offen lds
    s_add_u32 m0, s47, 16384
    s_add_u32 s46, s42, s43
    buffer_load_dwordx4 v10, s[8:11], s46 offen lds
    s_add_u32 m0, s47, 20480
    s_add_u32 s46, s42, s44
    buffer_load_dwordx4 v10, s[8:11], s46 offen lds
    s_add_u32 s38, s52, 1
    s_and_b32 s38, s38, 7
    s_mul_i32 s42, s38, s45
    s_add_u32 s42, s42, s53
    s_add_u32 m0, s47, 24576
    s_mov_b32 s46, s42
    buffer_load_dwordx4 v10, s[8:11], s46 offen lds
    s_add_u32 m0, s47, 28672
    s_add_u32 s46, s42, s43
    buffer_load_dwordx4 v10, s[8:11], s46 offen lds
    s_add_u32 m0, s47, 32768
    s_add_u32 s46, s42, s44
    buffer_load_dwordx4 v10, s[8:11], s46 offen lds
    s_add_u32 s38, s52, 1
    s_and_b32 s38, s38, 7
    s_lshl_b32 s38, s38, 7
    s_add_u32 s54, s49, s38
    s_cbranch_vccz L_fused_nohalo3
    s_add_u32 m0, s50, 90112
    s_add_u32 s46, s48, s38
    buffer_load_dwordx4 v11, s[4:7], s46 offen lds
L_fused_nohalo3:
    s_add_u32 m0, s50, 92160
    s_add_u32 s46, s54, 0
    buffer_load_dwordx4 v11, s[4:7], s46 offen lds
    s_add_u32 m0, s50, 96256
    s_add_u32 s46, s54, 32768
    buffer_load_dwordx4 v11, s[4:7], s46 offen lds
    s_add_u32 m0, s50, 100352
    s_add_u32 s46, s54, 65536
    buffer_load_dwordx4 v11, s[4:7], s46 offen lds
    s_add_u32 m0, s50, 104448
    s_add_u32 s46, s54, 98304
    buffer_load_dwordx4 v11, s[4:7], s46 offen lds
    s_lshr_b32 s38, s45, 1
    s_add_u32 s42, s42, s38
    s_add_u32 m0, s47, 36864
    s_mov_b32 s46, s42
    buffer_load_dwordx4 v10, s[8:11], s46 offen lds
    s_add_u32 m0, s47, 40960
    s_add_u32 s46, s42, s43
    buffer_load_dwordx4 v10, s[8:11], s46 offen lds
    s_add_u32 m0, s47, 45056
    s_add_u32 s46, s42, s44
    buffer_load_dwordx4 v10, s[8:11], s46 offen lds
    s_add_u32 s38, s52, 2
    s_and_b32 s38, s38, 7
    s_mul_i32 s42, s38, s45
    s_add_u32 s42, s42, s53
    s_add_u32 m0, s47, 49152
    s_mov_b32 s46, s42
    buffer_load_dwordx4 v10, s[8:11], s46 offen lds
    s_waitcnt vmcnt(14)
    s_barrier
    s_cmp_lg_u32 s2, 0
    s_cbranch_scc1 L_fused_nononce4
    s_cmp_lg_u32 s30, 7
    s_cbranch_scc1 L_fused_nononce4
    s_memrealtime s[38:39]
    s_waitcnt lgkmcnt(0)
    s_or_b32 s38, s38, 1
    v_mov_b32 v3, s38
    v_mov_b32 v4, 0
    s_mov_b64 exec, 1
    global_store_dword v4, v3, s[28:29] sc1
    s_mov_b64 exec, -1
L_fused_nononce4:
    s_add_u32 m0, s47, 53248
    s_add_u32 s46, s42, s43
    buffer_load_dwordx4 v10, s[8:11], s46 offen lds
    s_add_u32 m0, s47, 57344
    s_add_u32 s46, s42, s44
    buffer_load_dwordx4 v10, s[8:11], s46 offen lds
    s_add_u32 s38, s52, 2
    s_and_b32 s38, s38, 7
    s_lshl_b32 s38, s38, 7
    s_add_u32 s54, s49, s38
    s_cbranch_vccz L_fused_nohalo5
    s_add_u32 m0, s50, 108544
    s_add_u32 s46, s48, s38
    buffer_load_dwordx4 v11, s[4:7], s46 offen lds
L_fused_nohalo5:
    s_add_u32 m0, s50, 110592
    s_add_u32 s46, s54, 0
    buffer_load_dwordx4 v11, s[4:7], s46 offen lds
    s_add_u32 m0, s50, 114688
    s_add_u32 s46, s54, 32768
    buffer_load_dwordx4 v11, s[4:7], s46 offen lds
    s_add_u32 m0, s50, 118784
    s_add_u32 s46, s54, 65536
    buffer_load_dwordx4 v11, s[4:7], s46 offen lds
    s_add_u32 m0, s50, 122880
    s_add_u32 s46, s54, 98304
    buffer_load_dwordx4 v11, s[4:7], s46 offen lds
    s_lshr_b32 s38, s45, 1
    s_add_u32 s42, s42, s38
    s_add_u32 m0, s47, 61440
    s_mov_b32 s46, s42
    buffer_load_dwordx4 v10, s[8:11], s46 offen lds
    s_waitcnt vmcnt(18)
    s_barrier
    v_and_b32 v4, 15, v2
    v_lshrrev_b32 v5, 2, v4
    v_lshrrev_b32 v6, 5, v2
    v_lshl_add_u32 v6, v6, 3, v5
    v_lshlrev_b32 v6, 7, v6
    v_bfe_u32 v7, v2, 4, 1
    v_bfe_u32 v8, v4, 1, 1
    v_lshl_add_u32 v7, v7, 1, v8
    v_and_b32 v8, 2, v5
    v_lshlrev_b32 v8, 1, v8
    v_xor_b32 v7, v7, v8
    v_lshl_add_u32 v6, v7, 4, v6
    v_and_b32 v8, 1, v4
    v_lshl_add_u32 v6, v8, 3, v6
    s_lshl_b32 s61, s3, 15
    v_add_u32 v17, s61, v6
    v_xor_b32 v18, 64, v17
    s_sub_u32 s38, s3, 1
    s_mul_i32 s60, s38, 475136
    s_cmp_eq_u32 s3, 0
    s_cselect_b32 s60, 0, s60
    s_lshl_b32 s38, s41, 7
    s_add_u32 s60, s60, s38
    s_lshr_b32 s38, s30, 2
    s_lshl_b32 s39, s40, 1
    s_add_u32 s39, s39, s38
    s_mul_i32 s62, s39, 118
    s_mul_i32 s38, s3, 29
    s_add_u32 s38, s38, 3
    s_cmp_eq_u32 s3, 0
    s_cselect_b32 s38, 0, s38
    s_add_u32 s62, s62, s38
    s_lshl_b32 s62, s62, 10
    s_mov_b32 s56, 29
    s_cmp_eq_u32 s3, 0
    s_cselect_b32 s56, 32, s56
    s_cmp_eq_u32 s3, 3
    s_cselect_b32 s56, 28, s56
    s_lshl_b32 s38, s41, 2
    s_lshr_b32 s39, s32, 3
    s_lshl_b32 s39, s39, 3
    s_add_u32 s38, s38, s39
    s_mov_b32 s57, 0
    s_cmp_ge_u32 s57, s56
    s_cselect_b32 s39, s56, 0
    s_sub_u32 s57, s57, s39
    v_lshrrev_b32 v3, 3, v2
    v_and_b32 v4, 7, v2
    v_and_b32 v5, 2, v3
    v_lshlrev_b32 v5, 1, v5
    v_xor_b32 v5, v5, v4
    v_lshlrev_b32 v5, 4, v5
    v_lshl_add_u32 v12, v3, 10, v5
    s_lshl_b32 s55, s3, 11
    s_mov_b32 s58, s57
    s_add_u32 m0, s47, 65536
    s_add_u32 s46, s42, s43
    buffer_load_dwordx4 v10, s[8:11], s46 offen lds
    s_add_u32 m0, s47, 69632
    s_add_u32 s46, s42, s44
    buffer_load_dwordx4 v10, s[8:11], s46 offen lds
    s_add_u32 s38, s52, 3
    s_and_b32 s38, s38, 7
    s_mul_i32 s42, s38, s45
    s_add_u32 s42, s42, s53
    s_add_u32 m0, s47, 0
    s_mov_b32 s46, s42
    buffer_load_dwordx4 v10, s[8:11], s46 offen lds
    s_add_u32 m0, s47, 4096
    s_add_u32 s46, s42, s43
    buffer_load_dwordx4 v10, s[8:11], s46 offen lds
    s_add_u32 m0, s47, 8192
    s_add_u32 s46, s42, s44
    buffer_load_dwordx4 v10, s[8:11], s46 offen lds
    s_add_u32 s38, s52, 3
    s_and_b32 s38, s38, 7
    s_lshl_b32 s38, s38, 7
    s_add_u32 s54, s49, s38
    s_cbranch_vccz L_fused_nohalo6
    s_add_u32 m0, s50, 126976
    s_add_u32 s46, s48, s38
    buffer_load_dwordx4 v11, s[4:7], s46 offen lds
L_fused_nohalo6:
    s_add_u32 m0, s50, 129024
    s_add_u32 s46, s54, 0
    buffer_load_dwordx4 v11, s[4:7], s46 offen lds
    s_add_u32 m0, s50, 133120
    s_add_u32 s46, s54, 32768
    buffer_load_dwordx4 v11, s[4:7], s46 offen lds
    s_add_u32 m0, s50, 137216
    s_add_u32 s46, s54, 65536
    buffer_load_dwordx4 v11, s[4:7], s46 offen lds
    s_add_u32 m0, s50, 141312
    s_add_u32 s46, s54, 98304
    buffer_load_dwordx4 v11, s[4:7], s46 offen lds
    s_waitcnt vmcnt(20)
    s_barrier
    s_lshr_b32 s38, s45, 1
    s_add_u32 s42, s42, s38
    s_add_u32 m0, s47, 12288
    s_mov_b32 s46, s42
    buffer_load_dwordx4 v10, s[8:11], s46 offen lds
    s_add_u32 m0, s47, 16384
    s_add_u32 s46, s42, s43
    buffer_load_dwordx4 v10, s[8:11], s46 offen lds
    s_add_u32 m0, s47, 20480
    s_add_u32 s46, s42, s44
    buffer_load_dwordx4 v10, s[8:11], s46 offen lds
    s_lshl_b32 s38, s33, 7
    s_lshl_b32 s39, s34, 3
    s_add_u32 s38, s38, s39
    s_lshl_b32 s39, s36, 1
    s_add_u32 s63, s38, s39
    s_lshl_b32 s46, s63, 10
    s_mov_b32 s24, s78
    s_mov_b32 s25, s79
    s_mov_b32 s26, 1024
    s_mov_b32 s27, 0x20000
    buffer_load_dwordx4 v[20:23], v16, s[24:27], 0 offen
    buffer_load_dwordx4 v[24:27], v16, s[4:7], s46 offen
    buffer_load_dwordx4 v[28:31], v16, s[4:7], s46 offen offset:1024
    s_waitcnt vmcnt(23)
    s_barrier
    s_add_u32 s38, s52, 4
    s_and_b32 s38, s38, 7
    s_mul_i32 s42, s38, s45
    s_add_u32 s42, s42, s53
    s_add_u32 m0, s47, 24576
    s_mov_b32 s46, s42
    buffer_load_dwordx4 v10, s[8:11], s46 offen lds
    s_add_u32 m0, s47, 28672
    s_add_u32 s46, s42, s43
    buffer_load_dwordx4 v10, s[8:11], s46 offen lds
    s_add_u32 m0, s47, 32768
    s_add_u32 s46, s42, s44
    buffer_load_dwordx4 v10, s[8:11], s46 offen lds
    s_add_u32 s38, s52, 4
    s_and_b32 s38, s38, 7
    s_lshl_b32 s38, s38, 7
    s_add_u32 s54, s49, s38
    s_cbranch_vccz L_fused_nohalo7
    s_add_u32 m0, s50, 71680
    s_add_u32 s46, s48, s38
    buffer_load_dwordx4 v11, s[4:7], s46 offen lds
L_fused_nohalo7:
    s_add_u32 m0, s50, 73728
    s_add_u32 s46, s54, 0
    buffer_load_dwordx4 v11, s[4:7], s46 offen lds
    s_add_u32 m0, s50, 77824
    s_add_u32 s46, s54, 32768
    buffer_load_dwordx4 v11, s[4:7], s46 offen lds
    s_add_u32 m0, s50, 81920
    s_add_u32 s46, s54, 65536
    buffer_load_dwordx4 v11, s[4:7], s46 offen lds
    s_add_u32 m0, s50, 86016
    s_add_u32 s46, s54, 98304
    buffer_load_dwordx4 v11, s[4:7], s46 offen lds
    s_waitcnt vmcnt(23)
    s_barrier
    s_lshr_b32 s38, s45, 1
    s_add_u32 s42, s42, s38
    s_add_u32 m0, s47, 36864
    s_mov_b32 s46, s42
    buffer_load_dwordx4 v10, s[8:11], s46 offen lds
    s_add_u32 m0, s47, 40960
    s_add_u32 s46, s42, s43
    buffer_load_dwordx4 v10, s[8:11], s46 offen lds
    s_add_u32 m0, s47, 45056
    s_add_u32 s46, s42, s44
    buffer_load_dwordx4 v10, s[8:11], s46 offen lds
    s_waitcnt vmcnt(23)
    s_barrier
    s_add_u32 s38, s52, 5
    s_and_b32 s38, s38, 7
    s_mul_i32 s42, s38, s45
    s_add_u32 s42, s42, s53
    s_add_u32 m0, s47, 49152
    s_mov_b32 s46, s42
    buffer_load_dwordx4 v10, s[8:11], s46 offen lds
    s_add_u32 m0, s47, 53248
    s_add_u32 s46, s42, s43
    buffer_load_dwordx4 v10, s[8:11], s46 offen lds
    s_add_u32 m0, s47, 57344
    s_add_u32 s46, s42, s44
    buffer_load_dwordx4 v10, s[8:11], s46 offen lds
    s_add_u32 s38, s52, 5
    s_and_b32 s38, s38, 7
    s_lshl_b32 s38, s38, 7
    s_add_u32 s54, s49, s38
    s_cbranch_vccz L_fused_nohalo8
    s_add_u32 m0, s50, 90112
    s_add_u32 s46, s48, s38
    buffer_load_dwordx4 v11, s[4:7], s46 offen lds
L_fused_nohalo8:
    s_add_u32 m0, s50, 92160
    s_add_u32 s46, s54, 0
    buffer_load_dwordx4 v11, s[4:7], s46 offen lds
    s_add_u32 m0, s50, 96256
    s_add_u32 s46, s54, 32768
    buffer_load_dwordx4 v11, s[4:7], s46 offen lds
    s_add_u32 m0, s50, 100352
    s_add_u32 s46, s54, 65536
    buffer_load_dwordx4 v11, s[4:7], s46 offen lds
    s_add_u32 m0, s50, 104448
    s_add_u32 s46, s54, 98304
    buffer_load_dwordx4 v11, s[4:7], s46 offen lds
    s_waitcnt vmcnt(23)
    s_barrier
    s_lshr_b32 s38, s45, 1
    s_add_u32 s42, s42, s38
    s_add_u32 m0, s47, 61440
    s_mov_b32 s46, s42
    buffer_load_dwordx4 v10, s[8:11], s46 offen lds
    s_add_u32 m0, s47, 65536
    s_add_u32 s46, s42, s43
    buffer_load_dwordx4 v10, s[8:11], s46 offen lds
    s_add_u32 m0, s47, 69632
    s_add_u32 s46, s42, s44
    buffer_load_dwordx4 v10, s[8:11], s46 offen lds
    s_waitcnt vmcnt(23)
    s_barrier
    s_add_u32 s38, s52, 6
    s_and_b32 s38, s38, 7
    s_mul_i32 s42, s38, s45
    s_add_u32 s42, s42, s53
    s_add_u32 m0, s47, 0
    s_mov_b32 s46, s42
    buffer_load_dwordx4 v10, s[8:11], s46 offen lds
    s_add_u32 m0, s47, 4096
    s_add_u32 s46, s42, s43
    buffer_load_dwordx4 v10, s[8:11], s46 offen lds
    s_add_u32 m0, s47, 8192
    s_add_u32 s46, s42, s44
    buffer_load_dwordx4 v10, s[8:11], s46 offen lds
    s_add_u32 s38, s52, 6
    s_and_b32 s38, s38, 7
    s_lshl_b32 s38, s38, 7
    s_add_u32 s54, s49, s38
    s_cbranch_vccz L_fused_nohalo9
    s_add_u32 m0, s50, 108544
    s_add_u32 s46, s48, s38
    buffer_load_dwordx4 v11, s[4:7], s46 offen lds
L_fused_nohalo9:
    s_add_u32 m0, s50, 110592
    s_add_u32 s46, s54, 0
    buffer_load_dwordx4 v11, s[4:7], s46 offen lds
    s_add_u32 m0, s50, 114688
    s_add_u32 s46, s54, 32768
    buffer_load_dwordx4 v11, s[4:7], s46 offen lds
    s_add_u32 m0, s50, 118784
    s_add_u32 s46, s54, 65536
    buffer_load_dwordx4 v11, s[4:7], s46 offen lds
    s_add_u32 m0, s50, 122880
    s_add_u32 s46, s54, 98304
    buffer_load_dwordx4 v11, s[4:7], s46 offen lds
    s_waitcnt vmcnt(20)
    s_barrier
    s_lshr_b32 s38, s45, 1
    s_add_u32 s42, s42, s38
    s_add_u32 m0, s47, 12288
    s_mov_b32 s46, s42
    buffer_load_dwordx4 v10, s[8:11], s46 offen lds
    s_add_u32 m0, s47, 16384
    s_add_u32 s46, s42, s43
    buffer_load_dwordx4 v10, s[8:11], s46 offen lds
    s_add_u32 m0, s47, 20480
    s_add_u32 s46, s42, s44
    buffer_load_dwordx4 v10, s[8:11], s46 offen lds
    s_waitcnt vmcnt(20)
    s_barrier
    s_add_u32 s38, s52, 7
    s_and_b32 s38, s38, 7
    s_mul_i32 s42, s38, s45
    s_add_u32 s42, s42, s53
    s_add_u32 m0, s47, 24576
    s_mov_b32 s46, s42
    buffer_load_dwordx4 v10, s[8:11], s46 offen lds
    s_add_u32 m0, s47, 28672
    s_add_u32 s46, s42, s43
    buffer_load_dwordx4 v10, s[8:11], s46 offen lds
    s_add_u32 m0, s47, 32768
    s_add_u32 s46, s42, s44
    buffer_load_dwordx4 v10, s[8:11], s46 offen lds
    s_add_u32 s38, s52, 7
    s_and_b32 s38, s38, 7
    s_lshl_b32 s38, s38, 7
    s_add_u32 s54, s49, s38
    s_cbranch_vccz L_fused_nohalo10
    s_add_u32 m0, s50, 126976
    s_add_u32 s46, s48, s38
    buffer_load_dwordx4 v11, s[4:7], s46 offen lds
L_fused_nohalo10:
    s_add_u32 m0, s50, 129024
    s_add_u32 s46, s54, 0
    buffer_load_dwordx4 v11, s[4:7], s46 offen lds
    s_add_u32 m0, s50, 133120
    s_add_u32 s46, s54, 32768
    buffer_load_dwordx4 v11, s[4:7], s46 offen lds
    s_add_u32 m0, s50, 137216
    s_add_u32 s46, s54, 65536
    buffer_load_dwordx4 v11, s[4:7], s46 offen lds
    s_add_u32 m0, s50, 141312
    s_add_u32 s46, s54, 98304
    buffer_load_dwordx4 v11, s[4:7], s46 offen lds
    s_waitcnt vmcnt(20)
    s_barrier
    s_add_u32 m0, s55, 148480
    s_add_u32 s46, s60, 0
    buffer_load_dwordx4 v12, s[12:15], s46 offen lds
    s_add_u32 m0, s55, 149504
    s_add_u32 s46, s60, 8192
    buffer_load_dwordx4 v12, s[12:15], s46 offen lds
    s_lshr_b32 s38, s45, 1
    s_add_u32 s42, s42, s38
    s_add_u32 m0, s47, 36864
    s_mov_b32 s46, s42
    buffer_load_dwordx4 v10, s[8:11], s46 offen lds
    s_add_u32 m0, s47, 40960
    s_add_u32 s46, s42, s43
    buffer_load_dwordx4 v10, s[8:11], s46 offen lds
    s_add_u32 m0, s47, 45056
    s_add_u32 s46, s42, s44
    buffer_load_dwordx4 v10, s[8:11], s46 offen lds
    s_waitcnt vmcnt(22)
    s_barrier
    s_add_u32 m0, s55, 49152
    s_add_u32 s46, s60, 16384
    buffer_load_dwordx4 v12, s[12:15], s46 offen lds
    s_add_u32 m0, s55, 50176
    s_add_u32 s46, s60, 24576
    buffer_load_dwordx4 v12, s[12:15], s46 offen lds
    s_add_u32 m0, s55, 73728
    s_add_u32 s46, s60, 32768
    buffer_load_dwordx4 v12, s[12:15], s46 offen lds
    s_add_u32 m0, s55, 74752
    s_add_u32 s46, s60, 40960
    buffer_load_dwordx4 v12, s[12:15], s46 offen lds
    s_add_u32 m0, s55, 81920
    s_add_u32 s46, s60, 49152
    buffer_load_dwordx4 v12, s[12:15], s46 offen lds
    s_add_u32 m0, s55, 82944
    s_add_u32 s46, s60, 57344
    buffer_load_dwordx4 v12, s[12:15], s46 offen lds
    v_mov_b32 v32, 0
    v_mov_b32 v33, 0
    v_lshlrev_b32 v34, 16, v20
    v_and_b32 v35, 0xffff0000, v20
    v_lshlrev_b32 v36, 16, v24
    v_and_b32 v37, 0xffff0000, v24
    v_fmac_f32 v32, v34, v36
    v_fmac_f32 v32, v35, v37
    v_lshlrev_b32 v36, 16, v28
    v_and_b32 v37, 0xffff0000, v28
    v_fmac_f32 v33, v34, v36
    v_fmac_f32 v33, v35, v37
    v_lshlrev_b32 v34, 16, v21
    v_and_b32 v35, 0xffff0000, v21
    v_lshlrev_b32 v36, 16, v25
    v_and_b32 v37, 0xffff0000, v25
    v_fmac_f32 v32, v34, v36
    v_fmac_f32 v32, v35, v37
    v_lshlrev_b32 v36, 16, v29
    v_and_b32 v37, 0xffff0000, v29
    v_fmac_f32 v33, v34, v36
    v_fmac_f32 v33, v35, v37
    v_lshlrev_b32 v34, 16, v22
    v_and_b32 v35, 0xffff0000, v22
    v_lshlrev_b32 v36, 16, v26
    v_and_b32 v37, 0xffff0000, v26
    v_fmac_f32 v32, v34, v36
    v_fmac_f32 v32, v35, v37
    v_lshlrev_b32 v36, 16, v30
    v_and_b32 v37, 0xffff0000, v30
    v_fmac_f32 v33, v34, v36
    v_fmac_f32 v33, v35, v37
    v_lshlrev_b32 v34, 16, v23
    v_and_b32 v35, 0xffff0000, v23
    v_lshlrev_b32 v36, 16, v27
    v_and_b32 v37, 0xffff0000, v27
    v_fmac_f32 v32, v34, v36
    v_fmac_f32 v32, v35, v37
    v_lshlrev_b32 v36, 16, v31
    v_and_b32 v37, 0xffff0000, v31
    v_fmac_f32 v33, v34, v36
    v_fmac_f32 v33, v35, v37
    v_add_f32_dpp v32, v32, v32 row_ror:8 row_mask:0xf bank_mask:0xf
    s_nop 0
    v_add_f32_dpp v33, v33, v33 row_ror:8 row_mask:0xf bank_mask:0xf
    v_add_f32_dpp v32, v32, v32 row_ror:4 row_mask:0xf bank_mask:0xf
    s_nop 0
    v_add_f32_dpp v33, v33, v33 row_ror:4 row_mask:0xf bank_mask:0xf
    v_add_f32_dpp v32, v32, v32 row_ror:2 row_mask:0xf bank_mask:0xf
    s_nop 0
    v_add_f32_dpp v33, v33, v33 row_ror:2 row_mask:0xf bank_mask:0xf
    v_add_f32_dpp v32, v32, v32 row_ror:1 row_mask:0xf bank_mask:0xf
    s_nop 0
    v_add_f32_dpp v33, v33, v33 row_ror:1 row_mask:0xf bank_mask:0xf
    v_mov_b32 v34, v32
    v_mov_b32 v35, v33
    s_nop 0
    v_permlane16_swap_b32 v32, v34
    v_permlane16_swap_b32 v33, v35
    v_add_f32 v32, v32, v34
    v_add_f32 v33, v33, v35
    v_mov_b32 v34, v32
    v_mov_b32 v35, v33
    s_nop 0
    v_permlane32_swap_b32 v32, v34
    v_permlane32_swap_b32 v33, v35
    v_add_f32 v32, v32, v34
    v_add_f32 v33, v33, v35
    v_and_b32 v34, 1, v2
    v_cmp_eq_u32 s[42:43], 1, v34
    s_mov_b32 s38, 1069066811
    s_nop 0
    v_cndmask_b32 v32, v32, v33, s[42:43]
    v_mul_f32 v32, s38, v32
    v_exp_f32 v32, -v32
    s_nop 0
    v_add_f32 v32, 1.0, v32
    v_rcp_f32 v32, v32
    s_lshl_b32 s46, s63, 2
    s_add_u32 s46, s46, 7864320
    v_lshlrev_b32 v34, 2, v2
    s_mov_b64 exec, 3
    buffer_store_dword v32, v34, s[16:19], s46 offen sc1
    s_mov_b64 exec, -1
    s_waitcnt vmcnt(22)
    s_barrier
    s_add_u32 m0, s55, 57344
    s_add_u32 s46, s60, 65536
    buffer_load_dwordx4 v12, s[12:15], s46 offen lds
    s_add_u32 m0, s55, 58368
    s_add_u32 s46, s60, 73728
    buffer_load_dwordx4 v12, s[12:15], s46 offen lds
    s_add_u32 m0, s55, 65536
    s_add_u32 s46, s60, 81920
    buffer_load_dwordx4 v12, s[12:15], s46 offen lds
    s_add_u32 m0, s55, 66560
    s_add_u32 s46, s60, 90112
    buffer_load_dwordx4 v12, s[12:15], s46 offen lds
    s_waitcnt vmcnt(23)
    s_barrier
    s_add_u32 m0, s55, 0
    s_add_u32 s46, s60, 98304
    buffer_load_dwordx4 v12, s[12:15], s46 offen lds
    s_add_u32 m0, s55, 1024
    s_add_u32 s46, s60, 106496
    buffer_load_dwordx4 v12, s[12:15], s46 offen lds
    s_add_u32 m0, s55, 90112
    s_add_u32 s46, s60, 114688
    buffer_load_dwordx4 v12, s[12:15], s46 offen lds
    s_add_u32 m0, s55, 91136
    s_add_u32 s46, s60, 122880
    buffer_load_dwordx4 v12, s[12:15], s46 offen lds
    s_add_u32 m0, s55, 98304
    s_add_u32 s46, s60, 131072
    buffer_load_dwordx4 v12, s[12:15], s46 offen lds
    s_add_u32 m0, s55, 99328
    s_add_u32 s46, s60, 139264
    buffer_load_dwordx4 v12, s[12:15], s46 offen lds
    s_waitcnt vmcnt(22)
    s_barrier
    s_add_u32 m0, s55, 8192
    s_add_u32 s46, s60, 147456
    buffer_load_dwordx4 v12, s[12:15], s46 offen lds
    s_add_u32 m0, s55, 9216
    s_add_u32 s46, s60, 155648
    buffer_load_dwordx4 v12, s[12:15], s46 offen lds
    s_add_u32 m0, s55, 16384
    s_add_u32 s46, s60, 163840
    buffer_load_dwordx4 v12, s[12:15], s46 offen lds
    s_add_u32 m0, s55, 17408
    s_add_u32 s46, s60, 172032
    buffer_load_dwordx4 v12, s[12:15], s46 offen lds
    s_waitcnt vmcnt(21)
    s_barrier
    s_add_u32 m0, s55, 24576
    s_add_u32 s46, s60, 180224
    buffer_load_dwordx4 v12, s[12:15], s46 offen lds
    s_add_u32 m0, s55, 25600
    s_add_u32 s46, s60, 188416
    buffer_load_dwordx4 v12, s[12:15], s46 offen lds
    s_add_u32 m0, s55, 106496
    s_add_u32 s46, s60, 196608
    buffer_load_dwordx4 v12, s[12:15], s46 offen lds
    s_add_u32 m0, s55, 107520
    s_add_u32 s46, s60, 204800
    buffer_load_dwordx4 v12, s[12:15], s46 offen lds
    s_add_u32 m0, s55, 114688
    s_add_u32 s46, s60, 212992
    buffer_load_dwordx4 v12, s[12:15], s46 offen lds
    s_add_u32 m0, s55, 115712
    s_add_u32 s46, s60, 221184
    buffer_load_dwordx4 v12, s[12:15], s46 offen lds
    s_barrier
    s_add_u32 m0, s55, 32768
    s_add_u32 s46, s60, 229376
    buffer_load_dwordx4 v12, s[12:15], s46 offen lds
    s_add_u32 m0, s55, 33792
    s_add_u32 s46, s60, 237568
    buffer_load_dwordx4 v12, s[12:15], s46 offen lds
    s_add_u32 m0, s55, 40960
    s_add_u32 s46, s60, 245760
    buffer_load_dwordx4 v12, s[12:15], s46 offen lds
    s_add_u32 m0, s55, 41984
    s_add_u32 s46, s60, 253952
    buffer_load_dwordx4 v12, s[12:15], s46 offen lds
    s_waitcnt vmcnt(0)
    s_lshl_b32 s38, s3, 11
    s_sub_u32 s38, s38, s61
    v_add_u32 v20, s38, v17
    v_xor_b32 v21, 64, v20
    v_add_u32 v22, 0x10000, v20
    v_add_u32 v23, 0x10000, v21
    v_add_u32 v24, 0x20000, v20
    v_add_u32 v25, 0x20000, v21
    ds_read_b64_tr_b16 v[128:129], v24 offset:17408
    ds_read_b64_tr_b16 v[130:131], v24 offset:17920
    ds_read_b64_tr_b16 v[132:133], v25 offset:17408
    ds_read_b64_tr_b16 v[134:135], v25 offset:17920
    ds_read_b64_tr_b16 v[136:137], v20 offset:49152
    ds_read_b64_tr_b16 v[138:139], v20 offset:49664
    ds_read_b64_tr_b16 v[140:141], v21 offset:49152
    ds_read_b64_tr_b16 v[142:143], v21 offset:49664
    ds_read_b64_tr_b16 v[144:145], v22 offset:8192
    ds_read_b64_tr_b16 v[146:147], v22 offset:8704
    ds_read_b64_tr_b16 v[148:149], v23 offset:8192
    ds_read_b64_tr_b16 v[150:151], v23 offset:8704
    s_waitcnt lgkmcnt(4)
    ds_read_b64_tr_b16 v[152:153], v22 offset:16384
    ds_read_b64_tr_b16 v[154:155], v22 offset:16896
    ds_read_b64_tr_b16 v[156:157], v23 offset:16384
    ds_read_b64_tr_b16 v[158:159], v23 offset:16896
    ds_read_b64_tr_b16 v[160:161], v20 offset:57344
    ds_read_b64_tr_b16 v[162:163], v20 offset:57856
    ds_read_b64_tr_b16 v[164:165], v21 offset:57344
    ds_read_b64_tr_b16 v[166:167], v21 offset:57856
    ds_read_b64_tr_b16 v[168:169], v22 offset:0
    ds_read_b64_tr_b16 v[170:171], v22 offset:512
    ds_read_b64_tr_b16 v[172:173], v23 offset:0
    ds_read_b64_tr_b16 v[174:175], v23 offset:512
    s_waitcnt lgkmcnt(4)
    ds_read_b64_tr_b16 v[176:177], v20 offset:0
    ds_read_b64_tr_b16 v[178:179], v20 offset:512
    ds_read_b64_tr_b16 v[180:181], v21 offset:0
    ds_read_b64_tr_b16 v[182:183], v21 offset:512
    ds_read_b64_tr_b16 v[184:185], v22 offset:24576
    ds_read_b64_tr_b16 v[186:187], v22 offset:25088
    ds_read_b64_tr_b16 v[188:189], v23 offset:24576
    ds_read_b64_tr_b16 v[190:191], v23 offset:25088
    ds_read_b64_tr_b16 v[192:193], v22 offset:32768
    ds_read_b64_tr_b16 v[194:195], v22 offset:33280
    ds_read_b64_tr_b16 v[196:197], v23 offset:32768
    ds_read_b64_tr_b16 v[198:199], v23 offset:33280
    s_waitcnt lgkmcnt(4)
    ds_read_b64_tr_b16 v[200:201], v20 offset:8192
    ds_read_b64_tr_b16 v[202:203], v20 offset:8704
    ds_read_b64_tr_b16 v[204:205], v21 offset:8192
    ds_read_b64_tr_b16 v[206:207], v21 offset:8704
    ds_read_b64_tr_b16 v[208:209], v20 offset:16384
    ds_read_b64_tr_b16 v[210:211], v20 offset:16896
    ds_read_b64_tr_b16 v[212:213], v21 offset:16384
    ds_read_b64_tr_b16 v[214:215], v21 offset:16896
    ds_read_b64_tr_b16 v[216:217], v20 offset:24576
    ds_read_b64_tr_b16 v[218:219], v20 offset:25088
    ds_read_b64_tr_b16 v[220:221], v21 offset:24576
    ds_read_b64_tr_b16 v[222:223], v21 offset:25088
    s_waitcnt lgkmcnt(4)
    ds_read_b64_tr_b16 v[224:225], v22 offset:40960
    ds_read_b64_tr_b16 v[226:227], v22 offset:41472
    ds_read_b64_tr_b16 v[228:229], v23 offset:40960
    ds_read_b64_tr_b16 v[230:231], v23 offset:41472
    ds_read_b64_tr_b16 v[232:233], v22 offset:49152
    ds_read_b64_tr_b16 v[234:235], v22 offset:49664
    ds_read_b64_tr_b16 v[236:237], v23 offset:49152
    ds_read_b64_tr_b16 v[238:239], v23 offset:49664
    ds_read_b64_tr_b16 v[240:241], v20 offset:32768
    ds_read_b64_tr_b16 v[242:243], v20 offset:33280
    ds_read_b64_tr_b16 v[244:245], v21 offset:32768
    ds_read_b64_tr_b16 v[246:247], v21 offset:33280
    s_waitcnt lgkmcnt(4)
    ds_read_b64_tr_b16 v[248:249], v20 offset:40960
    ds_read_b64_tr_b16 v[250:251], v20 offset:41472
    ds_read_b64_tr_b16 v[252:253], v21 offset:40960
    ds_read_b64_tr_b16 v[254:255], v21 offset:41472
    s_waitcnt lgkmcnt(0)
    s_barrier
    s_barrier
    s_add_u32 m0, s61, 0
    s_add_u32 s46, s60, 262144
    buffer_load_dwordx4 v12, s[12:15], s46 offen lds
    s_add_u32 m0, s61, 1024
    s_add_u32 s46, s60, 270336
    buffer_load_dwordx4 v12, s[12:15], s46 offen lds
    s_add_u32 m0, s61, 2048
    s_add_u32 s46, s60, 278528
    buffer_load_dwordx4 v12, s[12:15], s46 offen lds
    s_add_u32 m0, s61, 3072
    s_add_u32 s46, s60, 286720
    buffer_load_dwordx4 v12, s[12:15], s46 offen lds
    s_add_u32 m0, s61, 4096
    s_add_u32 s46, s60, 294912
    buffer_load_dwordx4 v12, s[12:15], s46 offen lds
    s_add_u32 m0, s61, 5120
    s_add_u32 s46, s60, 303104
    buffer_load_dwordx4 v12, s[12:15], s46 offen lds
    s_add_u32 m0, s61, 6144
    s_add_u32 s46, s60, 311296
    buffer_load_dwordx4 v12, s[12:15], s46 offen lds
    s_add_u32 m0, s61, 7168
    s_add_u32 s46, s60, 319488
    buffer_load_dwordx4 v12, s[12:15], s46 offen lds
    s_add_u32 m0, s61, 8192
    s_add_u32 s46, s60, 327680
    buffer_load_dwordx4 v12, s[12:15], s46 offen lds
    s_add_u32 m0, s61, 9216
    s_add_u32 s46, s60, 335872
    buffer_load_dwordx4 v12, s[12:15], s46 offen lds
    s_add_u32 m0, s61, 10240
    s_add_u32 s46, s60, 344064
    buffer_load_dwordx4 v12, s[12:15], s46 offen lds
    s_add_u32 m0, s61, 11264
    s_add_u32 s46, s60, 352256
    buffer_load_dwordx4 v12, s[12:15], s46 offen lds
    s_add_u32 m0, s61, 12288
    s_add_u32 s46, s60, 360448
    buffer_load_dwordx4 v12, s[12:15], s46 offen lds
    s_add_u32 m0, s61, 13312
    s_add_u32 s46, s60, 368640
    buffer_load_dwordx4 v12, s[12:15], s46 offen lds
    s_add_u32 m0, s61, 14336
    s_add_u32 s46, s60, 376832
    buffer_load_dwordx4 v12, s[12:15], s46 offen lds
    s_add_u32 m0, s61, 15360
    s_add_u32 s46, s60, 385024
    buffer_load_dwordx4 v12, s[12:15], s46 offen lds
    s_add_u32 m0, s61, 16384
    s_add_u32 s46, s60, 393216
    buffer_load_dwordx4 v12, s[12:15], s46 offen lds
    s_add_u32 m0, s61, 17408
    s_add_u32 s46, s60, 401408
    buffer_load_dwordx4 v12, s[12:15], s46 offen lds
    s_add_u32 m0, s61, 18432
    s_add_u32 s46, s60, 409600
    buffer_load_dwordx4 v12, s[12:15], s46 offen lds
    s_add_u32 m0, s61, 19456
    s_add_u32 s46, s60, 417792
    buffer_load_dwordx4 v12, s[12:15], s46 offen lds
    s_add_u32 m0, s61, 20480
    s_add_u32 s46, s60, 425984
    buffer_load_dwordx4 v12, s[12:15], s46 offen lds
    s_add_u32 m0, s61, 21504
    s_add_u32 s46, s60, 434176
    buffer_load_dwordx4 v12, s[12:15], s46 offen lds
    s_add_u32 m0, s61, 22528
    s_add_u32 s46, s60, 442368
    buffer_load_dwordx4 v12, s[12:15], s46 offen lds
    s_add_u32 m0, s61, 23552
    s_add_u32 s46, s60, 450560
    buffer_load_dwordx4 v12, s[12:15], s46 offen lds
    s_cmp_ge_u32 s3, 3
    s_cbranch_scc1 L_fused_b2skip11
    s_add_u32 m0, s61, 24576
    s_add_u32 s46, s60, 458752
    buffer_load_dwordx4 v12, s[12:15], s46 offen lds
    s_add_u32 m0, s61, 25600
    s_add_u32 s46, s60, 466944
    buffer_load_dwordx4 v12, s[12:15], s46 offen lds
L_fused_b2skip11:
    s_cmp_ge_u32 s3, 1
    s_cbranch_scc1 L_fused_b2skip12
    s_add_u32 m0, s61, 26624
    s_add_u32 s46, s60, 475136
    buffer_load_dwordx4 v12, s[12:15], s46 offen lds
    s_add_u32 m0, s61, 27648
    s_add_u32 s46, s60, 483328
    buffer_load_dwordx4 v12, s[12:15], s46 offen lds
L_fused_b2skip12:
    s_cmp_ge_u32 s3, 1
    s_cbranch_scc1 L_fused_b2skip13
    s_add_u32 m0, s61, 28672
    s_add_u32 s46, s60, 491520
    buffer_load_dwordx4 v12, s[12:15], s46 offen lds
    s_add_u32 m0, s61, 29696
    s_add_u32 s46, s60, 499712
    buffer_load_dwordx4 v12, s[12:15], s46 offen lds
L_fused_b2skip13:
    s_cmp_ge_u32 s3, 1
    s_cbranch_scc1 L_fused_b2skip14
    s_add_u32 m0, s61, 30720
    s_add_u32 s46, s60, 507904
    buffer_load_dwordx4 v12, s[12:15], s46 offen lds
    s_add_u32 m0, s61, 31744
    s_add_u32 s46, s60, 516096
    buffer_load_dwordx4 v12, s[12:15], s46 offen lds
L_fused_b2skip14:
    s_lshl_b32 s38, s3, 2
    s_add_u32 s38, s38, 147488
    v_mov_b32 v6, s38
L_fused_spin15:
    ds_read_b32 v3, v6
    s_waitcnt lgkmcnt(0)
    v_readfirstlane_b32 s38, v3
    s_cmp_lt_u32 s38, 1
    s_cbranch_scc1 L_fused_spin15
    s_branch L_fused_phase2
L_fused_mfma:
    s_setprio 2
    s_getpc_b64 s[52:53]
L_fused_pc:
    s_cmp_lg_u32 s30, 0
    s_cbranch_scc1 L_fused_nocpf16
    s_sub_u32 s52, s52, L_fused_pc-L_fused_start
    s_subb_u32 s53, s53, 0
    s_lshl_b32 s38, s32, 10
    v_lshl_add_u32 v3, v2, 7, s38
    v_min_u32 v3, L_fused_codeend-L_fused_start-4, v3
    s_mov_b64 exec, 0xff
    global_load_dword v19, v3, s[52:53]
    s_mov_b64 exec, -1
L_fused_nocpf16:
    v_and_b32 v4, 15, v2
    v_lshrrev_b32 v5, 2, v4
    v_lshrrev_b32 v6, 5, v2
    v_lshl_add_u32 v6, v6, 3, v5
    v_lshlrev_b32 v6, 7, v6
    v_bfe_u32 v7, v2, 4, 1
    v_bfe_u32 v8, v4, 1, 1
    v_lshl_add_u32 v7, v7, 1, v8
    v_and_b32 v8, 2, v5
    v_lshlrev_b32 v8, 1, v8
    v_xor_b32 v7, v7, v8
    v_lshl_add_u32 v6, v7, 4, v6
    v_and_b32 v8, 1, v4
    v_lshl_add_u32 v6, v8, 3, v6
    s_lshl_b32 s61, s3, 15
    v_add_u32 v17, s61, v6
    v_xor_b32 v18, 64, v17
    s_sub_u32 s38, s3, 1
    s_mul_i32 s60, s38, 475136
    s_cmp_eq_u32 s3, 0
    s_cselect_b32 s60, 0, s60
    s_lshl_b32 s38, s41, 7
    s_add_u32 s60, s60, s38
    s_lshr_b32 s38, s30, 2
    s_lshl_b32 s39, s40, 1
    s_add_u32 s39, s39, s38
    s_mul_i32 s62, s39, 118
    s_mul_i32 s38, s3, 29
    s_add_u32 s38, s38, 3
    s_cmp_eq_u32 s3, 0
    s_cselect_b32 s38, 0, s38
    s_add_u32 s62, s62, s38
    s_lshl_b32 s62, s62, 10
    s_mov_b32 s56, 29
    s_cmp_eq_u32 s3, 0
    s_cselect_b32 s56, 32, s56
    s_cmp_eq_u32 s3, 3
    s_cselect_b32 s56, 28, s56
    s_lshl_b32 s38, s41, 2
    s_lshr_b32 s39, s32, 3
    s_lshl_b32 s39, s39, 3
    s_add_u32 s38, s38, s39
    s_mov_b32 s57, 0
    s_cmp_ge_u32 s57, s56
    s_cselect_b32 s39, s56, 0
    s_sub_u32 s57, s57, s39
    v_lshlrev_b32 v4, 2, v2
    v_add_u32 v4, 147456, v4
    v_mov_b32 v5, 0
    ds_write_b32 v4, v5
    v_lshrrev_b32 v3, 4, v2
    v_and_b32 v4, 15, v2
    v_lshrrev_b32 v5, 2, v4
    v_and_b32 v6, 2, v5
    v_bfe_u32 v7, v4, 1, 1
    s_lshl_b32 s38, s36, 1
    v_or_b32 v7, s38, v7
    v_xor_b32 v7, v7, v6
    v_and_b32 v6, 1, v3
    v_lshlrev_b32 v6, 2, v6
    v_xor_b32 v7, v7, v6
    v_lshlrev_b32 v7, 4, v7
    v_and_b32 v6, 1, v4
    v_lshl_add_u32 v7, v6, 3, v7
    v_lshl_add_u32 v7, v5, 7, v7
    v_lshl_add_u32 v10, v3, 10, v7
    v_add_u32 v11, 61440, v10
    v_lshrrev_b32 v5, 1, v4
    v_xor_b32 v5, v5, v3
    v_lshlrev_b32 v5, 4, v5
    v_lshl_add_u32 v5, v4, 7, v5
    v_add_u32 v12, 73728, v5
    v_xor_b32 v13, 64, v12
    v_add_u32 v14, 36864, v12
    v_add_u32 v15, 36864, v13
    s_cmp_eq_u32 s35, 0
    s_cbranch_scc0 L_fused_ffn
    s_waitcnt lgkmcnt(0)
    s_cmp_eq_u32 s3, 0
    s_cselect_b32 s12, s68, s76
    s_cselect_b32 s13, s69, s77
    s_mov_b32 s14, 0x158000
    s_cselect_b32 s14, 0x80000, s14
    s_mov_b32 s15, 0x20000
    s_mov_b32 s16, s84
    s_mov_b32 s17, s85
    s_mov_b32 s18, 0x800000
    s_mov_b32 s19, 0x20000
    s_mov_b32 s20, s80
    s_mov_b32 s21, s81
    s_mov_b32 s22, 0x200000
    s_mov_b32 s23, 0x20000
    s_mov_b32 s28, s82
    s_mov_b32 s29, s83
    s_cmp_eq_u32 s36, 3
    s_cbranch_scc1 L_fused_tw317
    v_mul_u32_u24 v20, 3277, v2
    v_lshrrev_b32 v20, 16, v20
    v_mul_u32_u24 v21, 20, v20
    v_sub_u32 v21, v2, v21
    s_mul_i32 s38, s36, 3
    s_max_u32 s38, s38, 1
    v_add_u32 v20, s38, v20
    v_cmp_gt_u32 s[42:43], 8, v20
    s_cmp_eq_u32 s36, 0
    s_mov_b32 s39, 60
    s_cselect_b32 s39, 40, s39
    v_cmp_gt_u32 vcc, s39, v2
    s_nop 3
    s_and_b64 s[42:43], s[42:43], vcc
    s_lshl_b32 s38, s2, 13
    v_lshl_add_u32 v22, v21, 10, s38
    v_lshl_add_u32 v22, v20, 7, v22
    v_mov_b32 v24, s64
    v_mov_b32 v25, s65
    s_mul_i32 s38, s2, 768
    v_subrev_u32 v23, 8, v21
    v_lshl_add_u32 v23, v23, 7, s38
    v_mul_u32_u24 v26, 196608, v20
    v_add_u32 v23, v23, v26
    v_cmp_le_u32 vcc, 8, v21
    v_mov_b32 v26, s66
    v_mov_b32 v27, s67
    v_cndmask_b32 v22, v22, v23, vcc
    v_cndmask_b32 v24, v24, v26, vcc
    v_cndmask_b32 v25, v25, v27, vcc
    s_mul_i32 s38, s2, 688
    v_subrev_u32 v23, 14, v21
    v_lshl_add_u32 v23, v23, 7, s38
    v_min_u32 v23, 176124, v23
    v_mul_u32_u24 v26, 176128, v20
    v_add_u32 v23, v23, v26
    v_cmp_le_u32 vcc, 14, v21
    v_mov_b32 v26, s72
    v_mov_b32 v27, s73
    v_cndmask_b32 v22, v22, v23, vcc
    v_cndmask_b32 v24, v24, v26, vcc
    v_cndmask_b32 v25, v25, v27, vcc
    s_branch L_fused_tdone18
L_fused_tw317:
    s_lshl_b32 s38, s2, 11
    v_lshl_add_u32 v22, v2, 7, s38
    v_mov_b32 v24, s68
    v_mov_b32 v25, s69
    s_mul_i32 s38, s2, 5504
    v_subrev_u32 v23, 16, v2
    v_lshl_add_u32 v23, v23, 7, s38
    v_min_u32 v23, 0x157ffc, v23
    v_cmp_le_u32 vcc, 16, v2
    v_mov_b32 v26, s76
    v_mov_b32 v27, s77
    v_cndmask_b32 v22, v22, v23, vcc
    v_cndmask_b32 v24, v24, v26, vcc
    v_cndmask_b32 v25, v25, v27, vcc
    v_cmp_gt_u32 s[42:43], 59, v2
L_fused_tdone18:
    v_add_co_u32 v30, vcc, v24, v22
    s_nop 1
    v_addc_co_u32 v31, vcc, 0, v25, vcc
    s_nop 3
    s_mov_b64 s[54:55], s[42:43]
    v_lshrrev_b32 v3, 4, v2
    v_and_b32 v4, 15, v2
    v_and_b32 v5, 1, v4
    v_cmp_eq_u32 s[42:43], 1, v5
    v_lshl_add_u32 v6, v3, 2, v5
    v_add_u32 v7, 2, v6
    v_cmp_le_u32 s[44:45], v6, v4
    v_cmp_le_u32 s[48:49], v7, v4
    v_mov_b32 v8, 0xffff
    v_mov_b32 v9, 0xffff0000
    v_cndmask_b32 v8, v8, v9, s[42:43]
    v_cndmask_b32 v20, 0, v8, s[44:45]
    v_cndmask_b32 v21, 0, v8, s[48:49]
    v_cndmask_b32 v22, v8, 0, s[44:45]
    v_cndmask_b32 v23, v8, 0, s[48:49]
    s_cmp_eq_u32 s33, 0
    s_cselect_b32 s38, 0xff7fffff, 0
    v_mov_b32 v9, s38
    v_cndmask_b32 v24, v9, 0, s[44:45]
    v_cndmask_b32 v25, v9, 0, s[48:49]
    v_mov_b32 v26, 0x3f803f80
    v_mov_b32 v27, 0x3f803f80
    v_mov_b32 v28, 0x3f803f80
    v_mov_b32 v29, 0x3f803f80
    s_mov_b32 s50, 0x3eb8aa3b
    s_and_b32 s38, s34, 7
    s_lshl_b32 s38, s38, 2
    s_add_u32 s38, s38, s36
    s_mul_i32 s51, s33, 472
    s_add_u32 s51, s51, s38
    s_lshl_b32 s51, s51, 10
    s_barrier
    ds_read_b64_tr_b16 v[140:141], v10 offset:0
    ds_read_b64_tr_b16 v[142:143], v10 offset:512
    ds_read_b64_tr_b16 v[144:145], v10 offset:4096
    ds_read_b64_tr_b16 v[146:147], v10 offset:4608
    ds_read_b64_tr_b16 v[148:149], v10 offset:8192
    ds_read_b64_tr_b16 v[150:151], v10 offset:8704
    ds_read_b128 v[164:167], v12 offset:0
    ds_read_b128 v[168:171], v12 offset:2048
    ds_read_b128 v[172:175], v12 offset:4096
    s_waitcnt lgkmcnt(2)
    v_mfma_f32_16x16x32_bf16 v[36:39], v[144:147], v[164:167], 0
    ds_read_b128 v[176:179], v12 offset:6144
    v_mfma_f32_16x16x32_bf16 v[40:43], v[164:167], v[148:151], 0
    s_waitcnt lgkmcnt(2)
    v_mfma_f32_16x16x32_bf16 v[44:47], v[140:143], v[168:171], 0
    ds_read_b128 v[164:167], v12 offset:8192
    v_mfma_f32_16x16x32_bf16 v[48:51], v[144:147], v[168:171], 0
    v_mfma_f32_16x16x32_bf16 v[52:55], v[168:171], v[148:151], 0
    s_waitcnt lgkmcnt(2)
    v_mfma_f32_16x16x32_bf16 v[56:59], v[140:143], v[172:175], 0
    ds_read_b128 v[168:171], v12 offset:10240
    v_mfma_f32_16x16x32_bf16 v[60:63], v[144:147], v[172:175], 0
    v_mfma_f32_16x16x32_bf16 v[64:67], v[172:175], v[148:151], 0
    s_waitcnt lgkmcnt(2)
    v_mfma_f32_16x16x32_bf16 v[68:71], v[140:143], v[176:179], 0
    ds_read_b128 v[172:175], v12 offset:12288
    v_mfma_f32_16x16x32_bf16 v[72:75], v[144:147], v[176:179], 0
    v_mfma_f32_16x16x32_bf16 v[76:79], v[176:179], v[148:151], 0
    s_barrier
    s_lshr_b32 s38, 8, s36
    s_bitcmp1_b32 s38, 0
    s_cbranch_scc0 L_fused_noti19
    s_mov_b64 exec, s[54:55]
    global_load_dword v19, v[30:31], off
    s_mov_b64 exec, -1
L_fused_noti19:
    s_waitcnt lgkmcnt(2)
    v_mfma_f32_16x16x32_bf16 v[80:83], v[140:143], v[164:167], 0
    ds_read_b128 v[176:179], v12 offset:14336
    v_mfma_f32_16x16x32_bf16 v[84:87], v[144:147], v[164:167], 0
    ds_read_b64_tr_b16 v[152:153], v10 offset:12288
    ds_read_b64_tr_b16 v[154:155], v10 offset:12800
    v_mfma_f32_16x16x32_bf16 v[88:91], v[164:167], v[148:151], 0
    s_waitcnt lgkmcnt(4)
    v_mfma_f32_16x16x32_bf16 v[92:95], v[140:143], v[168:171], 0
    ds_read_b128 v[164:167], v12 offset:16384
    v_mfma_f32_16x16x32_bf16 v[96:99], v[144:147], v[168:171], 0
    ds_read_b64_tr_b16 v[156:157], v10 offset:16384
    ds_read_b64_tr_b16 v[158:159], v10 offset:16896
    v_mfma_f32_16x16x32_bf16 v[100:103], v[168:171], v[148:151], 0
    s_waitcnt lgkmcnt(6)
    v_mfma_f32_16x16x32_bf16 v[104:107], v[140:143], v[172:175], 0
    ds_read_b128 v[168:171], v13 offset:0
    v_mfma_f32_16x16x32_bf16 v[108:111], v[144:147], v[172:175], 0
    ds_read_b64_tr_b16 v[160:161], v10 offset:20480
    ds_read_b64_tr_b16 v[162:163], v10 offset:20992
    v_mfma_f32_16x16x32_bf16 v[112:115], v[172:175], v[148:151], 0
    s_waitcnt lgkmcnt(8)
    v_mfma_f32_16x16x32_bf16 v[116:119], v[140:143], v[176:179], 0
    ds_read_b128 v[172:175], v13 offset:2048
    v_mfma_f32_16x16x32_bf16 v[120:123], v[144:147], v[176:179], 0
    v_mfma_f32_16x16x32_bf16 v[124:127], v[176:179], v[148:151], 0
    s_waitcnt lgkmcnt(6)
    v_mfma_f32_16x16x32_bf16 v[128:131], v[140:143], v[164:167], 0
    ds_read_b128 v[176:179], v13 offset:4096
    v_mfma_f32_16x16x32_bf16 v[132:135], v[144:147], v[164:167], 0
    v_mfma_f32_16x16x32_bf16 v[136:139], v[164:167], v[148:151], 0
    s_waitcnt lgkmcnt(2)
    v_mfma_f32_16x16x32_bf16 v[36:39], v[156:159], v[168:171], v[36:39]
    ds_read_b128 v[164:167], v13 offset:6144
    v_mfma_f32_16x16x32_bf16 v[40:43], v[168:171], v[160:163], v[40:43]
    s_waitcnt lgkmcnt(2)
    v_mfma_f32_16x16x32_bf16 v[44:47], v[152:155], v[172:175], v[44:47]
    ds_read_b128 v[168:171], v13 offset:8192
    v_mfma_f32_16x16x32_bf16 v[48:51], v[156:159], v[172:175], v[48:51]
    v_mfma_f32_16x16x32_bf16 v[52:55], v[172:175], v[160:163], v[52:55]
    s_waitcnt lgkmcnt(2)
    v_mfma_f32_16x16x32_bf16 v[56:59], v[152:155], v[176:179], v[56:59]
    ds_read_b128 v[172:175], v13 offset:10240
    v_mfma_f32_16x16x32_bf16 v[60:63], v[156:159], v[176:179], v[60:63]
    v_mfma_f32_16x16x32_bf16 v[64:67], v[176:179], v[160:163], v[64:67]
    s_waitcnt lgkmcnt(2)
    v_mfma_f32_16x16x32_bf16 v[68:71], v[152:155], v[164:167], v[68:71]
    ds_read_b128 v[176:179], v13 offset:12288
    v_mfma_f32_16x16x32_bf16 v[72:75], v[156:159], v[164:167], v[72:75]
    v_mfma_f32_16x16x32_bf16 v[76:79], v[164:167], v[160:163], v[76:79]
    s_barrier
    s_waitcnt lgkmcnt(2)
    v_mfma_f32_16x16x32_bf16 v[80:83], v[152:155], v[168:171], v[80:83]
    ds_read_b128 v[164:167], v13 offset:14336
    v_mfma_f32_16x16x32_bf16 v[84:87], v[156:159], v[168:171], v[84:87]
    ds_read_b64_tr_b16 v[140:141], v10 offset:24576
    ds_read_b64_tr_b16 v[142:143], v10 offset:25088
    v_mfma_f32_16x16x32_bf16 v[88:91], v[168:171], v[160:163], v[88:91]
    s_waitcnt lgkmcnt(4)
    v_mfma_f32_16x16x32_bf16 v[92:95], v[152:155], v[172:175], v[92:95]
    ds_read_b128 v[168:171], v13 offset:16384
    v_mfma_f32_16x16x32_bf16 v[96:99], v[156:159], v[172:175], v[96:99]
    ds_read_b64_tr_b16 v[144:145], v10 offset:28672
    ds_read_b64_tr_b16 v[146:147], v10 offset:29184
    v_mfma_f32_16x16x32_bf16 v[100:103], v[172:175], v[160:163], v[100:103]
    s_waitcnt lgkmcnt(6)
    v_mfma_f32_16x16x32_bf16 v[104:107], v[152:155], v[176:179], v[104:107]
    ds_read_b128 v[172:175], v12 offset:18432
    v_mfma_f32_16x16x32_bf16 v[108:111], v[156:159], v[176:179], v[108:111]
    ds_read_b64_tr_b16 v[148:149], v10 offset:32768
    ds_read_b64_tr_b16 v[150:151], v10 offset:33280
    v_mfma_f32_16x16x32_bf16 v[112:115], v[176:179], v[160:163], v[112:115]
    s_waitcnt lgkmcnt(8)
    v_mfma_f32_16x16x32_bf16 v[116:119], v[152:155], v[164:167], v[116:119]
    ds_read_b128 v[176:179], v12 offset:20480
    v_mfma_f32_16x16x32_bf16 v[120:123], v[156:159], v[164:167], v[120:123]
    v_mfma_f32_16x16x32_bf16 v[124:127], v[164:167], v[160:163], v[124:127]
    s_waitcnt lgkmcnt(6)
    v_mfma_f32_16x16x32_bf16 v[128:131], v[152:155], v[168:171], v[128:131]
    ds_read_b128 v[164:167], v12 offset:22528
    v_mfma_f32_16x16x32_bf16 v[132:135], v[156:159], v[168:171], v[132:135]
    v_mfma_f32_16x16x32_bf16 v[136:139], v[168:171], v[160:163], v[136:139]
    s_waitcnt lgkmcnt(2)
    v_mfma_f32_16x16x32_bf16 v[36:39], v[144:147], v[172:175], v[36:39]
    ds_read_b128 v[168:171], v12 offset:24576
    v_mfma_f32_16x16x32_bf16 v[40:43], v[172:175], v[148:151], v[40:43]
    s_waitcnt lgkmcnt(2)
    v_mfma_f32_16x16x32_bf16 v[44:47], v[140:143], v[176:179], v[44:47]
    ds_read_b128 v[172:175], v12 offset:26624
    v_mfma_f32_16x16x32_bf16 v[48:51], v[144:147], v[176:179], v[48:51]
    v_mfma_f32_16x16x32_bf16 v[52:55], v[176:179], v[148:151], v[52:55]
    s_waitcnt lgkmcnt(2)
    v_mfma_f32_16x16x32_bf16 v[56:59], v[140:143], v[164:167], v[56:59]
    ds_read_b128 v[176:179], v12 offset:28672
    v_mfma_f32_16x16x32_bf16 v[60:63], v[144:147], v[164:167], v[60:63]
    v_mfma_f32_16x16x32_bf16 v[64:67], v[164:167], v[148:151], v[64:67]
    s_waitcnt lgkmcnt(2)
    v_mfma_f32_16x16x32_bf16 v[68:71], v[140:143], v[168:171], v[68:71]
    ds_read_b128 v[164:167], v12 offset:30720
    v_mfma_f32_16x16x32_bf16 v[72:75], v[144:147], v[168:171], v[72:75]
    v_mfma_f32_16x16x32_bf16 v[76:79], v[168:171], v[148:151], v[76:79]
    s_barrier
    s_cmp_lg_u32 s30, 3
    s_cbranch_scc1 L_fused_nfw20
    s_lshl_b32 s38, s40, 3
    s_add_u32 s38, s38, s41
    s_lshl_b32 s38, s38, 7
    s_add_u32 s46, s38, 7929856
    v_mov_b32 v4, 0
    s_mov_b64 exec, 1
    buffer_load_dword v19, v4, s[16:19], s46 offen sc1
    s_mov_b64 exec, -1
L_fused_nfw20:
    s_waitcnt lgkmcnt(2)
    v_mfma_f32_16x16x32_bf16 v[80:83], v[140:143], v[172:175], v[80:83]
    ds_read_b128 v[168:171], v12 offset:32768
    v_mfma_f32_16x16x32_bf16 v[84:87], v[144:147], v[172:175], v[84:87]
    ds_read_b64_tr_b16 v[152:153], v10 offset:36864
    ds_read_b64_tr_b16 v[154:155], v10 offset:37376
    v_mfma_f32_16x16x32_bf16 v[88:91], v[172:175], v[148:151], v[88:91]
    s_waitcnt lgkmcnt(4)
    v_mfma_f32_16x16x32_bf16 v[92:95], v[140:143], v[176:179], v[92:95]
    ds_read_b128 v[172:175], v12 offset:34816
    v_mfma_f32_16x16x32_bf16 v[96:99], v[144:147], v[176:179], v[96:99]
    ds_read_b64_tr_b16 v[156:157], v10 offset:40960
    ds_read_b64_tr_b16 v[158:159], v10 offset:41472
    v_mfma_f32_16x16x32_bf16 v[100:103], v[176:179], v[148:151], v[100:103]
    s_waitcnt lgkmcnt(6)
    v_mfma_f32_16x16x32_bf16 v[104:107], v[140:143], v[164:167], v[104:107]
    ds_read_b128 v[176:179], v13 offset:18432
    v_mfma_f32_16x16x32_bf16 v[108:111], v[144:147], v[164:167], v[108:111]
    ds_read_b64_tr_b16 v[160:161], v10 offset:45056
    ds_read_b64_tr_b16 v[162:163], v10 offset:45568
    v_mfma_f32_16x16x32_bf16 v[112:115], v[164:167], v[148:151], v[112:115]
    s_waitcnt lgkmcnt(8)
    v_mfma_f32_16x16x32_bf16 v[116:119], v[140:143], v[168:171], v[116:119]
    ds_read_b128 v[164:167], v13 offset:20480
    v_mfma_f32_16x16x32_bf16 v[120:123], v[144:147], v[168:171], v[120:123]
    v_mfma_f32_16x16x32_bf16 v[124:127], v[168:171], v[148:151], v[124:127]
    s_waitcnt lgkmcnt(6)
    v_mfma_f32_16x16x32_bf16 v[128:131], v[140:143], v[172:175], v[128:131]
    ds_read_b128 v[168:171], v13 offset:22528
    v_mfma_f32_16x16x32_bf16 v[132:135], v[144:147], v[172:175], v[132:135]
    v_mfma_f32_16x16x32_bf16 v[136:139], v[172:175], v[148:151], v[136:139]
    s_waitcnt lgkmcnt(2)
    v_mfma_f32_16x16x32_bf16 v[36:39], v[156:159], v[176:179], v[36:39]
    ds_read_b128 v[172:175], v13 offset:24576
    v_mfma_f32_16x16x32_bf16 v[40:43], v[176:179], v[160:163], v[40:43]
    s_waitcnt lgkmcnt(2)
    v_mfma_f32_16x16x32_bf16 v[44:47], v[152:155], v[164:167], v[44:47]
    ds_read_b128 v[176:179], v13 offset:26624
    v_mfma_f32_16x16x32_bf16 v[48:51], v[156:159], v[164:167], v[48:51]
    v_mfma_f32_16x16x32_bf16 v[52:55], v[164:167], v[160:163], v[52:55]
    s_waitcnt lgkmcnt(2)
    v_mfma_f32_16x16x32_bf16 v[56:59], v[152:155], v[168:171], v[56:59]
    ds_read_b128 v[164:167], v13 offset:28672
    v_mfma_f32_16x16x32_bf16 v[60:63], v[156:159], v[168:171], v[60:63]
    v_mfma_f32_16x16x32_bf16 v[64:67], v[168:171], v[160:163], v[64:67]
    s_waitcnt lgkmcnt(2)
    v_mfma_f32_16x16x32_bf16 v[68:71], v[152:155], v[172:175], v[68:71]
    ds_read_b128 v[168:171], v13 offset:30720
    v_mfma_f32_16x16x32_bf16 v[72:75], v[156:159], v[172:175], v[72:75]
    v_mfma_f32_16x16x32_bf16 v[76:79], v[172:175], v[160:163], v[76:79]
    s_barrier
    s_waitcnt lgkmcnt(2)
    v_mfma_f32_16x16x32_bf16 v[80:83], v[152:155], v[176:179], v[80:83]
    ds_read_b128 v[172:175], v13 offset:32768
    v_mfma_f32_16x16x32_bf16 v[84:87], v[156:159], v[176:179], v[84:87]
    ds_read_b64_tr_b16 v[140:141], v10 offset:49152
    ds_read_b64_tr_b16 v[142:143], v10 offset:49664
    v_mfma_f32_16x16x32_bf16 v[88:91], v[176:179], v[160:163], v[88:91]
    s_waitcnt lgkmcnt(4)
    v_mfma_f32_16x16x32_bf16 v[92:95], v[152:155], v[164:167], v[92:95]
    ds_read_b128 v[176:179], v13 offset:34816
    v_mfma_f32_16x16x32_bf16 v[96:99], v[156:159], v[164:167], v[96:99]
    ds_read_b64_tr_b16 v[144:145], v10 offset:53248
    ds_read_b64_tr_b16 v[146:147], v10 offset:53760
    v_mfma_f32_16x16x32_bf16 v[100:103], v[164:167], v[160:163], v[100:103]
    s_waitcnt lgkmcnt(6)
    v_mfma_f32_16x16x32_bf16 v[104:107], v[152:155], v[168:171], v[104:107]
    ds_read_b128 v[164:167], v14 offset:0
    v_mfma_f32_16x16x32_bf16 v[108:111], v[156:159], v[168:171], v[108:111]
    ds_read_b64_tr_b16 v[148:149], v10 offset:57344
    ds_read_b64_tr_b16 v[150:151], v10 offset:57856
    v_mfma_f32_16x16x32_bf16 v[112:115], v[168:171], v[160:163], v[112:115]
    s_waitcnt lgkmcnt(8)
    v_mfma_f32_16x16x32_bf16 v[116:119], v[152:155], v[172:175], v[116:119]
    ds_read_b128 v[168:171], v14 offset:2048
    v_mfma_f32_16x16x32_bf16 v[120:123], v[156:159], v[172:175], v[120:123]
    v_mfma_f32_16x16x32_bf16 v[124:127], v[172:175], v[160:163], v[124:127]
    s_waitcnt lgkmcnt(6)
    v_mfma_f32_16x16x32_bf16 v[128:131], v[152:155], v[176:179], v[128:131]
    ds_read_b128 v[172:175], v14 offset:4096
    v_mfma_f32_16x16x32_bf16 v[132:135], v[156:159], v[176:179], v[132:135]
    v_mfma_f32_16x16x32_bf16 v[136:139], v[176:179], v[160:163], v[136:139]
    s_waitcnt lgkmcnt(2)
    v_mfma_f32_16x16x32_bf16 v[36:39], v[144:147], v[164:167], v[36:39]
    ds_read_b128 v[176:179], v14 offset:6144
    v_mfma_f32_16x16x32_bf16 v[40:43], v[164:167], v[148:151], v[40:43]
    s_waitcnt lgkmcnt(2)
    v_mfma_f32_16x16x32_bf16 v[44:47], v[140:143], v[168:171], v[44:47]
    ds_read_b128 v[164:167], v14 offset:8192
    v_mfma_f32_16x16x32_bf16 v[48:51], v[144:147], v[168:171], v[48:51]
    v_mfma_f32_16x16x32_bf16 v[52:55], v[168:171], v[148:151], v[52:55]
    s_waitcnt lgkmcnt(2)
    v_mfma_f32_16x16x32_bf16 v[56:59], v[140:143], v[172:175], v[56:59]
    ds_read_b128 v[168:171], v14 offset:10240
    v_mfma_f32_16x16x32_bf16 v[60:63], v[144:147], v[172:175], v[60:63]
    v_mfma_f32_16x16x32_bf16 v[64:67], v[172:175], v[148:151], v[64:67]
    s_waitcnt lgkmcnt(2)
    v_mfma_f32_16x16x32_bf16 v[68:71], v[140:143], v[176:179], v[68:71]
    ds_read_b128 v[172:175], v14 offset:12288
    v_mfma_f32_16x16x32_bf16 v[72:75], v[144:147], v[176:179], v[72:75]
    v_mfma_f32_16x16x32_bf16 v[76:79], v[176:179], v[148:151], v[76:79]
    s_barrier
    s_waitcnt lgkmcnt(2)
    v_mfma_f32_16x16x32_bf16 v[80:83], v[140:143], v[164:167], v[80:83]
    ds_read_b128 v[176:179], v14 offset:14336
    v_mfma_f32_16x16x32_bf16 v[84:87], v[144:147], v[164:167], v[84:87]
    ds_read_b64_tr_b16 v[152:153], v11 offset:0
    ds_read_b64_tr_b16 v[154:155], v11 offset:512
    v_mfma_f32_16x16x32_bf16 v[88:91], v[164:167], v[148:151], v[88:91]
    s_waitcnt lgkmcnt(4)
    v_mfma_f32_16x16x32_bf16 v[92:95], v[140:143], v[168:171], v[92:95]
    ds_read_b128 v[164:167], v14 offset:16384
    v_mfma_f32_16x16x32_bf16 v[96:99], v[144:147], v[168:171], v[96:99]
    ds_read_b64_tr_b16 v[156:157], v11 offset:4096
    ds_read_b64_tr_b16 v[158:159], v11 offset:4608
    v_mfma_f32_16x16x32_bf16 v[100:103], v[168:171], v[148:151], v[100:103]
    s_waitcnt lgkmcnt(6)
    v_mfma_f32_16x16x32_bf16 v[104:107], v[140:143], v[172:175], v[104:107]
    ds_read_b128 v[168:171], v15 offset:0
    v_mfma_f32_16x16x32_bf16 v[108:111], v[144:147], v[172:175], v[108:111]
    ds_read_b64_tr_b16 v[160:161], v11 offset:8192
    ds_read_b64_tr_b16 v[162:163], v11 offset:8704
    v_mfma_f32_16x16x32_bf16 v[112:115], v[172:175], v[148:151], v[112:115]
    s_waitcnt lgkmcnt(8)
    v_mfma_f32_16x16x32_bf16 v[116:119], v[140:143], v[176:179], v[116:119]
    ds_read_b128 v[172:175], v15 offset:2048
    v_mfma_f32_16x16x32_bf16 v[120:123], v[144:147], v[176:179], v[120:123]
    v_mfma_f32_16x16x32_bf16 v[124:127], v[176:179], v[148:151], v[124:127]
    s_waitcnt lgkmcnt(6)
    v_mfma_f32_16x16x32_bf16 v[128:131], v[140:143], v[164:167], v[128:131]
    ds_read_b128 v[176:179], v15 offset:4096
    v_mfma_f32_16x16x32_bf16 v[132:135], v[144:147], v[164:167], v[132:135]
    v_mfma_f32_16x16x32_bf16 v[136:139], v[164:167], v[148:151], v[136:139]
    s_waitcnt lgkmcnt(2)
    v_mfma_f32_16x16x32_bf16 v[36:39], v[156:159], v[168:171], v[36:39]
    ds_read_b128 v[164:167], v15 offset:6144
    v_mfma_f32_16x16x32_bf16 v[40:43], v[168:171], v[160:163], v[40:43]
    s_waitcnt lgkmcnt(2)
    v_mfma_f32_16x16x32_bf16 v[44:47], v[152:155], v[172:175], v[44:47]
    ds_read_b128 v[168:171], v15 offset:8192
    v_mfma_f32_16x16x32_bf16 v[48:51], v[156:159], v[172:175], v[48:51]
    v_mfma_f32_16x16x32_bf16 v[52:55], v[172:175], v[160:163], v[52:55]
    s_waitcnt lgkmcnt(2)
    v_mfma_f32_16x16x32_bf16 v[56:59], v[152:155], v[176:179], v[56:59]
    ds_read_b128 v[172:175], v15 offset:10240
    v_mfma_f32_16x16x32_bf16 v[60:63], v[156:159], v[176:179], v[60:63]
    v_mfma_f32_16x16x32_bf16 v[64:67], v[176:179], v[160:163], v[64:67]
    s_waitcnt lgkmcnt(2)
    v_mfma_f32_16x16x32_bf16 v[68:71], v[152:155], v[164:167], v[68:71]
    ds_read_b128 v[176:179], v15 offset:12288
    v_mfma_f32_16x16x32_bf16 v[72:75], v[156:159], v[164:167], v[72:75]
    v_mfma_f32_16x16x32_bf16 v[76:79], v[164:167], v[160:163], v[76:79]
    s_barrier
    s_waitcnt lgkmcnt(2)
    v_mfma_f32_16x16x32_bf16 v[80:83], v[152:155], v[168:171], v[80:83]
    ds_read_b128 v[164:167], v15 offset:14336
    v_mfma_f32_16x16x32_bf16 v[84:87], v[156:159], v[168:171], v[84:87]
    ds_read_b64_tr_b16 v[140:141], v10 offset:0
    ds_read_b64_tr_b16 v[142:143], v10 offset:512
    v_mfma_f32_16x16x32_bf16 v[88:91], v[168:171], v[160:163], v[88:91]
    s_waitcnt lgkmcnt(4)
    v_mfma_f32_16x16x32_bf16 v[92:95], v[152:155], v[172:175], v[92:95]
    ds_read_b128 v[168:171], v15 offset:16384
    v_mfma_f32_16x16x32_bf16 v[96:99], v[156:159], v[172:175], v[96:99]
    ds_read_b64_tr_b16 v[144:145], v10 offset:4096
    ds_read_b64_tr_b16 v[146:147], v10 offset:4608
    v_mfma_f32_16x16x32_bf16 v[100:103], v[172:175], v[160:163], v[100:103]
    s_waitcnt lgkmcnt(6)
    v_mfma_f32_16x16x32_bf16 v[104:107], v[152:155], v[176:179], v[104:107]
    ds_read_b128 v[172:175], v14 offset:18432
    v_mfma_f32_16x16x32_bf16 v[108:111], v[156:159], v[176:179], v[108:111]
    ds_read_b64_tr_b16 v[148:149], v10 offset:8192
    ds_read_b64_tr_b16 v[150:151], v10 offset:8704
    v_mfma_f32_16x16x32_bf16 v[112:115], v[176:179], v[160:163], v[112:115]
    s_waitcnt lgkmcnt(8)
    v_mfma_f32_16x16x32_bf16 v[116:119], v[152:155], v[164:167], v[116:119]
    ds_read_b128 v[176:179], v14 offset:20480
    v_mfma_f32_16x16x32_bf16 v[120:123], v[156:159], v[164:167], v[120:123]
    v_mfma_f32_16x16x32_bf16 v[124:127], v[164:167], v[160:163], v[124:127]
    s_waitcnt lgkmcnt(6)
    v_mfma_f32_16x16x32_bf16 v[128:131], v[152:155], v[168:171], v[128:131]
    ds_read_b128 v[164:167], v14 offset:22528
    v_mfma_f32_16x16x32_bf16 v[132:135], v[156:159], v[168:171], v[132:135]
    v_mfma_f32_16x16x32_bf16 v[136:139], v[168:171], v[160:163], v[136:139]
    s_waitcnt lgkmcnt(2)
    v_mfma_f32_16x16x32_bf16 v[36:39], v[144:147], v[172:175], v[36:39]
    ds_read_b128 v[168:171], v14 offset:24576
    v_mfma_f32_16x16x32_bf16 v[40:43], v[172:175], v[148:151], v[40:43]
    s_waitcnt lgkmcnt(2)
    v_mfma_f32_16x16x32_bf16 v[44:47], v[140:143], v[176:179], v[44:47]
    ds_read_b128 v[172:175], v14 offset:26624
    v_mfma_f32_16x16x32_bf16 v[48:51], v[144:147], v[176:179], v[48:51]
    v_mfma_f32_16x16x32_bf16 v[52:55], v[176:179], v[148:151], v[52:55]
    s_waitcnt lgkmcnt(2)
    v_mfma_f32_16x16x32_bf16 v[56:59], v[140:143], v[164:167], v[56:59]
    ds_read_b128 v[176:179], v14 offset:28672
    v_mfma_f32_16x16x32_bf16 v[60:63], v[144:147], v[164:167], v[60:63]
    v_mfma_f32_16x16x32_bf16 v[64:67], v[164:167], v[148:151], v[64:67]
    s_waitcnt lgkmcnt(2)
    v_mfma_f32_16x16x32_bf16 v[68:71], v[140:143], v[168:171], v[68:71]
    ds_read_b128 v[164:167], v14 offset:30720
    v_mfma_f32_16x16x32_bf16 v[72:75], v[144:147], v[168:171], v[72:75]
    v_mfma_f32_16x16x32_bf16 v[76:79], v[168:171], v[148:151], v[76:79]
    s_barrier
    s_waitcnt lgkmcnt(2)
    v_mfma_f32_16x16x32_bf16 v[80:83], v[140:143], v[172:175], v[80:83]
    ds_read_b128 v[168:171], v14 offset:32768
    v_mfma_f32_16x16x32_bf16 v[84:87], v[144:147], v[172:175], v[84:87]
    ds_read_b64_tr_b16 v[152:153], v10 offset:12288
    ds_read_b64_tr_b16 v[154:155], v10 offset:12800
    v_mfma_f32_16x16x32_bf16 v[88:91], v[172:175], v[148:151], v[88:91]
    s_waitcnt lgkmcnt(4)
    v_mfma_f32_16x16x32_bf16 v[92:95], v[140:143], v[176:179], v[92:95]
    ds_read_b128 v[172:175], v14 offset:34816
    v_mfma_f32_16x16x32_bf16 v[96:99], v[144:147], v[176:179], v[96:99]
    ds_read_b64_tr_b16 v[156:157], v10 offset:16384
    ds_read_b64_tr_b16 v[158:159], v10 offset:16896
    v_mfma_f32_16x16x32_bf16 v[100:103], v[176:179], v[148:151], v[100:103]
    s_waitcnt lgkmcnt(6)
    v_mfma_f32_16x16x32_bf16 v[104:107], v[140:143], v[164:167], v[104:107]
    ds_read_b128 v[176:179], v15 offset:18432
    v_mfma_f32_16x16x32_bf16 v[108:111], v[144:147], v[164:167], v[108:111]
    ds_read_b64_tr_b16 v[160:161], v10 offset:20480
    ds_read_b64_tr_b16 v[162:163], v10 offset:20992
    v_mfma_f32_16x16x32_bf16 v[112:115], v[164:167], v[148:151], v[112:115]
    s_waitcnt lgkmcnt(8)
    v_mfma_f32_16x16x32_bf16 v[116:119], v[140:143], v[168:171], v[116:119]
    ds_read_b128 v[164:167], v15 offset:20480
    v_mfma_f32_16x16x32_bf16 v[120:123], v[144:147], v[168:171], v[120:123]
    v_mfma_f32_16x16x32_bf16 v[124:127], v[168:171], v[148:151], v[124:127]
    s_waitcnt lgkmcnt(6)
    v_mfma_f32_16x16x32_bf16 v[128:131], v[140:143], v[172:175], v[128:131]
    ds_read_b128 v[168:171], v15 offset:22528
    v_mfma_f32_16x16x32_bf16 v[132:135], v[144:147], v[172:175], v[132:135]
    v_mfma_f32_16x16x32_bf16 v[136:139], v[172:175], v[148:151], v[136:139]
    s_waitcnt lgkmcnt(2)
    v_mfma_f32_16x16x32_bf16 v[36:39], v[156:159], v[176:179], v[36:39]
    ds_read_b128 v[172:175], v15 offset:24576
    v_mfma_f32_16x16x32_bf16 v[40:43], v[176:179], v[160:163], v[40:43]
    s_waitcnt lgkmcnt(2)
    v_mfma_f32_16x16x32_bf16 v[44:47], v[152:155], v[164:167], v[44:47]
    ds_read_b128 v[176:179], v15 offset:26624
    v_mfma_f32_16x16x32_bf16 v[48:51], v[156:159], v[164:167], v[48:51]
    v_mfma_f32_16x16x32_bf16 v[52:55], v[164:167], v[160:163], v[52:55]
    s_waitcnt lgkmcnt(2)
    v_mfma_f32_16x16x32_bf16 v[56:59], v[152:155], v[168:171], v[56:59]
    ds_read_b128 v[164:167], v15 offset:28672
    v_mfma_f32_16x16x32_bf16 v[60:63], v[156:159], v[168:171], v[60:63]
    v_mfma_f32_16x16x32_bf16 v[64:67], v[168:171], v[160:163], v[64:67]
    s_waitcnt lgkmcnt(2)
    v_mfma_f32_16x16x32_bf16 v[68:71], v[152:155], v[172:175], v[68:71]
    ds_read_b128 v[168:171], v15 offset:30720
    v_mfma_f32_16x16x32_bf16 v[72:75], v[156:159], v[172:175], v[72:75]
    v_mfma_f32_16x16x32_bf16 v[76:79], v[172:175], v[160:163], v[76:79]
    s_barrier
    s_waitcnt lgkmcnt(2)
    v_mfma_f32_16x16x32_bf16 v[80:83], v[152:155], v[176:179], v[80:83]
    ds_read_b128 v[172:175], v15 offset:32768
    v_mfma_f32_16x16x32_bf16 v[84:87], v[156:159], v[176:179], v[84:87]
    ds_read_b64_tr_b16 v[140:141], v10 offset:24576
    ds_read_b64_tr_b16 v[142:143], v10 offset:25088
    v_mfma_f32_16x16x32_bf16 v[88:91], v[176:179], v[160:163], v[88:91]
    s_waitcnt lgkmcnt(4)
    v_mfma_f32_16x16x32_bf16 v[92:95], v[152:155], v[164:167], v[92:95]
    ds_read_b128 v[176:179], v15 offset:34816
    v_mfma_f32_16x16x32_bf16 v[96:99], v[156:159], v[164:167], v[96:99]
    ds_read_b64_tr_b16 v[144:145], v10 offset:28672
    ds_read_b64_tr_b16 v[146:147], v10 offset:29184
    v_mfma_f32_16x16x32_bf16 v[100:103], v[164:167], v[160:163], v[100:103]
    s_waitcnt lgkmcnt(6)
    v_mfma_f32_16x16x32_bf16 v[104:107], v[152:155], v[168:171], v[104:107]
    ds_read_b128 v[164:167], v12 offset:0
    v_mfma_f32_16x16x32_bf16 v[108:111], v[156:159], v[168:171], v[108:111]
    ds_read_b64_tr_b16 v[148:149], v10 offset:32768
    ds_read_b64_tr_b16 v[150:151], v10 offset:33280
    v_mfma_f32_16x16x32_bf16 v[112:115], v[168:171], v[160:163], v[112:115]
    s_waitcnt lgkmcnt(8)
    v_mfma_f32_16x16x32_bf16 v[116:119], v[152:155], v[172:175], v[116:119]
    ds_read_b128 v[168:171], v12 offset:2048
    v_mfma_f32_16x16x32_bf16 v[120:123], v[156:159], v[172:175], v[120:123]
    v_mfma_f32_16x16x32_bf16 v[124:127], v[172:175], v[160:163], v[124:127]
    s_waitcnt lgkmcnt(6)
    v_mfma_f32_16x16x32_bf16 v[128:131], v[152:155], v[176:179], v[128:131]
    ds_read_b128 v[172:175], v12 offset:4096
    v_mfma_f32_16x16x32_bf16 v[132:135], v[156:159], v[176:179], v[132:135]
    v_mfma_f32_16x16x32_bf16 v[136:139], v[176:179], v[160:163], v[136:139]
    s_waitcnt lgkmcnt(2)
    v_mfma_f32_16x16x32_bf16 v[36:39], v[144:147], v[164:167], v[36:39]
    ds_read_b128 v[176:179], v12 offset:6144
    v_mfma_f32_16x16x32_bf16 v[40:43], v[164:167], v[148:151], v[40:43]
    s_waitcnt lgkmcnt(2)
    v_mfma_f32_16x16x32_bf16 v[44:47], v[140:143], v[168:171], v[44:47]
    ds_read_b128 v[164:167], v12 offset:8192
    v_mfma_f32_16x16x32_bf16 v[48:51], v[144:147], v[168:171], v[48:51]
    v_mfma_f32_16x16x32_bf16 v[52:55], v[168:171], v[148:151], v[52:55]
    s_waitcnt lgkmcnt(2)
    v_mfma_f32_16x16x32_bf16 v[56:59], v[140:143], v[172:175], v[56:59]
    ds_read_b128 v[168:171], v12 offset:10240
    v_mfma_f32_16x16x32_bf16 v[60:63], v[144:147], v[172:175], v[60:63]
    v_mfma_f32_16x16x32_bf16 v[64:67], v[172:175], v[148:151], v[64:67]
    s_waitcnt lgkmcnt(2)
    v_mfma_f32_16x16x32_bf16 v[68:71], v[140:143], v[176:179], v[68:71]
    ds_read_b128 v[172:175], v12 offset:12288
    v_mfma_f32_16x16x32_bf16 v[72:75], v[144:147], v[176:179], v[72:75]
    v_mfma_f32_16x16x32_bf16 v[76:79], v[176:179], v[148:151], v[76:79]
    s_barrier
    s_waitcnt lgkmcnt(2)
    v_mfma_f32_16x16x32_bf16 v[80:83], v[140:143], v[164:167], v[80:83]
    ds_read_b128 v[176:179], v12 offset:14336
    v_mfma_f32_16x16x32_bf16 v[84:87], v[144:147], v[164:167], v[84:87]
    ds_read_b64_tr_b16 v[152:153], v10 offset:36864
    ds_read_b64_tr_b16 v[154:155], v10 offset:37376
    v_mfma_f32_16x16x32_bf16 v[88:91], v[164:167], v[148:151], v[88:91]
    s_waitcnt lgkmcnt(4)
    v_mfma_f32_16x16x32_bf16 v[92:95], v[140:143], v[168:171], v[92:95]
    ds_read_b128 v[164:167], v12 offset:16384
    v_mfma_f32_16x16x32_bf16 v[96:99], v[144:147], v[168:171], v[96:99]
    ds_read_b64_tr_b16 v[156:157], v10 offset:40960
    ds_read_b64_tr_b16 v[158:159], v10 offset:41472
    v_mfma_f32_16x16x32_bf16 v[100:103], v[168:171], v[148:151], v[100:103]
    s_waitcnt lgkmcnt(6)
    v_mfma_f32_16x16x32_bf16 v[104:107], v[140:143], v[172:175], v[104:107]
    ds_read_b128 v[168:171], v13 offset:0
    v_mfma_f32_16x16x32_bf16 v[108:111], v[144:147], v[172:175], v[108:111]
    ds_read_b64_tr_b16 v[160:161], v10 offset:45056
    ds_read_b64_tr_b16 v[162:163], v10 offset:45568
    v_mfma_f32_16x16x32_bf16 v[112:115], v[172:175], v[148:151], v[112:115]
    s_waitcnt lgkmcnt(8)
    v_mfma_f32_16x16x32_bf16 v[116:119], v[140:143], v[176:179], v[116:119]
    ds_read_b128 v[172:175], v13 offset:2048
    v_mfma_f32_16x16x32_bf16 v[120:123], v[144:147], v[176:179], v[120:123]
    v_mfma_f32_16x16x32_bf16 v[124:127], v[176:179], v[148:151], v[124:127]
    s_waitcnt lgkmcnt(6)
    v_mfma_f32_16x16x32_bf16 v[128:131], v[140:143], v[164:167], v[128:131]
    ds_read_b128 v[176:179], v13 offset:4096
    v_mfma_f32_16x16x32_bf16 v[132:135], v[144:147], v[164:167], v[132:135]
    v_mfma_f32_16x16x32_bf16 v[136:139], v[164:167], v[148:151], v[136:139]
    s_waitcnt lgkmcnt(2)
    v_mfma_f32_16x16x32_bf16 v[36:39], v[156:159], v[168:171], v[36:39]
    ds_read_b128 v[164:167], v13 offset:6144
    v_mfma_f32_16x16x32_bf16 v[40:43], v[168:171], v[160:163], v[40:43]
    s_waitcnt lgkmcnt(2)
    v_mfma_f32_16x16x32_bf16 v[44:47], v[152:155], v[172:175], v[44:47]
    ds_read_b128 v[168:171], v13 offset:8192
    v_mfma_f32_16x16x32_bf16 v[48:51], v[156:159], v[172:175], v[48:51]
    v_mfma_f32_16x16x32_bf16 v[52:55], v[172:175], v[160:163], v[52:55]
    s_waitcnt lgkmcnt(2)
    v_mfma_f32_16x16x32_bf16 v[56:59], v[152:155], v[176:179], v[56:59]
    ds_read_b128 v[172:175], v13 offset:10240
    v_mfma_f32_16x16x32_bf16 v[60:63], v[156:159], v[176:179], v[60:63]
    v_mfma_f32_16x16x32_bf16 v[64:67], v[176:179], v[160:163], v[64:67]
    s_waitcnt lgkmcnt(2)
    v_mfma_f32_16x16x32_bf16 v[68:71], v[152:155], v[164:167], v[68:71]
    ds_read_b128 v[176:179], v13 offset:12288
    v_mfma_f32_16x16x32_bf16 v[72:75], v[156:159], v[164:167], v[72:75]
    v_mfma_f32_16x16x32_bf16 v[76:79], v[164:167], v[160:163], v[76:79]
    s_barrier
    s_waitcnt lgkmcnt(2)
    v_mfma_f32_16x16x32_bf16 v[80:83], v[152:155], v[168:171], v[80:83]
    ds_read_b128 v[164:167], v13 offset:14336
    v_mfma_f32_16x16x32_bf16 v[84:87], v[156:159], v[168:171], v[84:87]
    ds_read_b64_tr_b16 v[140:141], v10 offset:49152
    ds_read_b64_tr_b16 v[142:143], v10 offset:49664
    v_mfma_f32_16x16x32_bf16 v[88:91], v[168:171], v[160:163], v[88:91]
    s_waitcnt lgkmcnt(4)
    v_mfma_f32_16x16x32_bf16 v[92:95], v[152:155], v[172:175], v[92:95]
    ds_read_b128 v[168:171], v13 offset:16384
    v_mfma_f32_16x16x32_bf16 v[96:99], v[156:159], v[172:175], v[96:99]
    ds_read_b64_tr_b16 v[144:145], v10 offset:53248
    ds_read_b64_tr_b16 v[146:147], v10 offset:53760
    v_mfma_f32_16x16x32_bf16 v[100:103], v[172:175], v[160:163], v[100:103]
    s_waitcnt lgkmcnt(6)
    v_mfma_f32_16x16x32_bf16 v[104:107], v[152:155], v[176:179], v[104:107]
    ds_read_b128 v[172:175], v12 offset:18432
    v_mfma_f32_16x16x32_bf16 v[108:111], v[156:159], v[176:179], v[108:111]
    ds_read_b64_tr_b16 v[148:149], v10 offset:57344
    ds_read_b64_tr_b16 v[150:151], v10 offset:57856
    v_mfma_f32_16x16x32_bf16 v[112:115], v[176:179], v[160:163], v[112:115]
    s_waitcnt lgkmcnt(8)
    v_mfma_f32_16x16x32_bf16 v[116:119], v[152:155], v[164:167], v[116:119]
    ds_read_b128 v[176:179], v12 offset:20480
    v_mfma_f32_16x16x32_bf16 v[120:123], v[156:159], v[164:167], v[120:123]
    v_mfma_f32_16x16x32_bf16 v[124:127], v[164:167], v[160:163], v[124:127]
    s_waitcnt lgkmcnt(6)
    v_mfma_f32_16x16x32_bf16 v[128:131], v[152:155], v[168:171], v[128:131]
    ds_read_b128 v[164:167], v12 offset:22528
    v_mfma_f32_16x16x32_bf16 v[132:135], v[156:159], v[168:171], v[132:135]
    v_mfma_f32_16x16x32_bf16 v[136:139], v[168:171], v[160:163], v[136:139]
    s_waitcnt lgkmcnt(2)
    v_mfma_f32_16x16x32_bf16 v[36:39], v[144:147], v[172:175], v[36:39]
    ds_read_b128 v[168:171], v12 offset:24576
    v_mfma_f32_16x16x32_bf16 v[40:43], v[172:175], v[148:151], v[40:43]
    s_waitcnt lgkmcnt(2)
    v_mfma_f32_16x16x32_bf16 v[44:47], v[140:143], v[176:179], v[44:47]
    ds_read_b128 v[172:175], v12 offset:26624
    v_mfma_f32_16x16x32_bf16 v[48:51], v[144:147], v[176:179], v[48:51]
    v_mfma_f32_16x16x32_bf16 v[52:55], v[176:179], v[148:151], v[52:55]
    s_waitcnt lgkmcnt(2)
    v_mfma_f32_16x16x32_bf16 v[56:59], v[140:143], v[164:167], v[56:59]
    ds_read_b128 v[176:179], v12 offset:28672
    v_mfma_f32_16x16x32_bf16 v[60:63], v[144:147], v[164:167], v[60:63]
    v_mfma_f32_16x16x32_bf16 v[64:67], v[164:167], v[148:151], v[64:67]
    s_waitcnt lgkmcnt(2)
    v_mfma_f32_16x16x32_bf16 v[68:71], v[140:143], v[168:171], v[68:71]
    ds_read_b128 v[164:167], v12 offset:30720
    v_mfma_f32_16x16x32_bf16 v[72:75], v[144:147], v[168:171], v[72:75]
    v_mfma_f32_16x16x32_bf16 v[76:79], v[168:171], v[148:151], v[76:79]
    s_barrier
    s_waitcnt lgkmcnt(2)
    v_mfma_f32_16x16x32_bf16 v[80:83], v[140:143], v[172:175], v[80:83]
    ds_read_b128 v[168:171], v12 offset:32768
    v_mfma_f32_16x16x32_bf16 v[84:87], v[144:147], v[172:175], v[84:87]
    ds_read_b64_tr_b16 v[152:153], v11 offset:0
    ds_read_b64_tr_b16 v[154:155], v11 offset:512
    v_mfma_f32_16x16x32_bf16 v[88:91], v[172:175], v[148:151], v[88:91]
    s_waitcnt lgkmcnt(4)
    v_mfma_f32_16x16x32_bf16 v[92:95], v[140:143], v[176:179], v[92:95]
    ds_read_b128 v[172:175], v12 offset:34816
    v_mfma_f32_16x16x32_bf16 v[96:99], v[144:147], v[176:179], v[96:99]
    ds_read_b64_tr_b16 v[156:157], v11 offset:4096
    ds_read_b64_tr_b16 v[158:159], v11 offset:4608
    v_mfma_f32_16x16x32_bf16 v[100:103], v[176:179], v[148:151], v[100:103]
    s_waitcnt lgkmcnt(6)
    v_mfma_f32_16x16x32_bf16 v[104:107], v[140:143], v[164:167], v[104:107]
    ds_read_b128 v[176:179], v13 offset:18432
    v_mfma_f32_16x16x32_bf16 v[108:111], v[144:147], v[164:167], v[108:111]
    ds_read_b64_tr_b16 v[160:161], v11 offset:8192
    ds_read_b64_tr_b16 v[162:163], v11 offset:8704
    v_mfma_f32_16x16x32_bf16 v[112:115], v[164:167], v[148:151], v[112:115]
    s_waitcnt lgkmcnt(8)
    v_mfma_f32_16x16x32_bf16 v[116:119], v[140:143], v[168:171], v[116:119]
    ds_read_b128 v[164:167], v13 offset:20480
    v_mfma_f32_16x16x32_bf16 v[120:123], v[144:147], v[168:171], v[120:123]
    v_mfma_f32_16x16x32_bf16 v[124:127], v[168:171], v[148:151], v[124:127]
    s_waitcnt lgkmcnt(6)
    v_mfma_f32_16x16x32_bf16 v[128:131], v[140:143], v[172:175], v[128:131]
    ds_read_b128 v[168:171], v13 offset:22528
    v_mfma_f32_16x16x32_bf16 v[132:135], v[144:147], v[172:175], v[132:135]
    v_mfma_f32_16x16x32_bf16 v[136:139], v[172:175], v[148:151], v[136:139]
    s_waitcnt lgkmcnt(2)
    v_mfma_f32_16x16x32_bf16 v[36:39], v[156:159], v[176:179], v[36:39]
    ds_read_b128 v[172:175], v13 offset:24576
    v_mfma_f32_16x16x32_bf16 v[40:43], v[176:179], v[160:163], v[40:43]
    s_waitcnt lgkmcnt(2)
    v_mfma_f32_16x16x32_bf16 v[44:47], v[152:155], v[164:167], v[44:47]
    ds_read_b128 v[176:179], v13 offset:26624
    v_mfma_f32_16x16x32_bf16 v[48:51], v[156:159], v[164:167], v[48:51]
    v_mfma_f32_16x16x32_bf16 v[52:55], v[164:167], v[160:163], v[52:55]
    s_waitcnt lgkmcnt(2)
    v_mfma_f32_16x16x32_bf16 v[56:59], v[152:155], v[168:171], v[56:59]
    ds_read_b128 v[164:167], v13 offset:28672
    v_mfma_f32_16x16x32_bf16 v[60:63], v[156:159], v[168:171], v[60:63]
    v_mfma_f32_16x16x32_bf16 v[64:67], v[168:171], v[160:163], v[64:67]
    s_waitcnt lgkmcnt(2)
    v_mfma_f32_16x16x32_bf16 v[68:71], v[152:155], v[172:175], v[68:71]
    ds_read_b128 v[168:171], v13 offset:30720
    v_mfma_f32_16x16x32_bf16 v[72:75], v[156:159], v[172:175], v[72:75]
    v_mfma_f32_16x16x32_bf16 v[76:79], v[172:175], v[160:163], v[76:79]
    s_barrier
    s_waitcnt lgkmcnt(2)
    v_mfma_f32_16x16x32_bf16 v[80:83], v[152:155], v[176:179], v[80:83]
    ds_read_b128 v[172:175], v13 offset:32768
    v_mfma_f32_16x16x32_bf16 v[84:87], v[156:159], v[176:179], v[84:87]
    ds_read_b64_tr_b16 v[140:141], v10 offset:0
    ds_read_b64_tr_b16 v[142:143], v10 offset:512
    v_mfma_f32_16x16x32_bf16 v[88:91], v[176:179], v[160:163], v[88:91]
    s_waitcnt lgkmcnt(4)
    v_mfma_f32_16x16x32_bf16 v[92:95], v[152:155], v[164:167], v[92:95]
    ds_read_b128 v[176:179], v13 offset:34816
    v_mfma_f32_16x16x32_bf16 v[96:99], v[156:159], v[164:167], v[96:99]
    ds_read_b64_tr_b16 v[144:145], v10 offset:4096
    ds_read_b64_tr_b16 v[146:147], v10 offset:4608
    v_mfma_f32_16x16x32_bf16 v[100:103], v[164:167], v[160:163], v[100:103]
    s_waitcnt lgkmcnt(6)
    v_mfma_f32_16x16x32_bf16 v[104:107], v[152:155], v[168:171], v[104:107]
    ds_read_b128 v[164:167], v14 offset:0
    v_mfma_f32_16x16x32_bf16 v[108:111], v[156:159], v[168:171], v[108:111]
    ds_read_b64_tr_b16 v[148:149], v10 offset:8192
    ds_read_b64_tr_b16 v[150:151], v10 offset:8704
    v_mfma_f32_16x16x32_bf16 v[112:115], v[168:171], v[160:163], v[112:115]
    s_waitcnt lgkmcnt(8)
    v_mfma_f32_16x16x32_bf16 v[116:119], v[152:155], v[172:175], v[116:119]
    ds_read_b128 v[168:171], v14 offset:2048
    v_mfma_f32_16x16x32_bf16 v[120:123], v[156:159], v[172:175], v[120:123]
    v_mfma_f32_16x16x32_bf16 v[124:127], v[172:175], v[160:163], v[124:127]
    s_waitcnt lgkmcnt(6)
    v_mfma_f32_16x16x32_bf16 v[128:131], v[152:155], v[176:179], v[128:131]
    ds_read_b128 v[172:175], v14 offset:4096
    v_mfma_f32_16x16x32_bf16 v[132:135], v[156:159], v[176:179], v[132:135]
    v_mfma_f32_16x16x32_bf16 v[136:139], v[176:179], v[160:163], v[136:139]
    s_waitcnt lgkmcnt(2)
    v_mfma_f32_16x16x32_bf16 v[36:39], v[144:147], v[164:167], v[36:39]
    ds_read_b128 v[176:179], v14 offset:6144
    v_mfma_f32_16x16x32_bf16 v[40:43], v[164:167], v[148:151], v[40:43]
    s_waitcnt lgkmcnt(2)
    v_mfma_f32_16x16x32_bf16 v[44:47], v[140:143], v[168:171], v[44:47]
    ds_read_b128 v[164:167], v14 offset:8192
    v_mfma_f32_16x16x32_bf16 v[48:51], v[144:147], v[168:171], v[48:51]
    v_mfma_f32_16x16x32_bf16 v[52:55], v[168:171], v[148:151], v[52:55]
    s_waitcnt lgkmcnt(2)
    v_mfma_f32_16x16x32_bf16 v[56:59], v[140:143], v[172:175], v[56:59]
    ds_read_b128 v[168:171], v14 offset:10240
    v_mfma_f32_16x16x32_bf16 v[60:63], v[144:147], v[172:175], v[60:63]
    v_mfma_f32_16x16x32_bf16 v[64:67], v[172:175], v[148:151], v[64:67]
    s_waitcnt lgkmcnt(2)
    v_mfma_f32_16x16x32_bf16 v[68:71], v[140:143], v[176:179], v[68:71]
    ds_read_b128 v[172:175], v14 offset:12288
    v_mfma_f32_16x16x32_bf16 v[72:75], v[144:147], v[176:179], v[72:75]
    v_mfma_f32_16x16x32_bf16 v[76:79], v[176:179], v[148:151], v[76:79]
    s_barrier
    s_waitcnt lgkmcnt(2)
    v_mfma_f32_16x16x32_bf16 v[80:83], v[140:143], v[164:167], v[80:83]
    ds_read_b128 v[176:179], v14 offset:14336
    v_mfma_f32_16x16x32_bf16 v[84:87], v[144:147], v[164:167], v[84:87]
    ds_read_b64_tr_b16 v[152:153], v10 offset:12288
    ds_read_b64_tr_b16 v[154:155], v10 offset:12800
    v_mfma_f32_16x16x32_bf16 v[88:91], v[164:167], v[148:151], v[88:91]
    s_waitcnt lgkmcnt(4)
    v_mfma_f32_16x16x32_bf16 v[92:95], v[140:143], v[168:171], v[92:95]
    ds_read_b128 v[164:167], v14 offset:16384
    v_mfma_f32_16x16x32_bf16 v[96:99], v[144:147], v[168:171], v[96:99]
    ds_read_b64_tr_b16 v[156:157], v10 offset:16384
    ds_read_b64_tr_b16 v[158:159], v10 offset:16896
    v_mfma_f32_16x16x32_bf16 v[100:103], v[168:171], v[148:151], v[100:103]
    s_waitcnt lgkmcnt(6)
    v_mfma_f32_16x16x32_bf16 v[104:107], v[140:143], v[172:175], v[104:107]
    ds_read_b128 v[168:171], v15 offset:0
    v_mfma_f32_16x16x32_bf16 v[108:111], v[144:147], v[172:175], v[108:111]
    ds_read_b64_tr_b16 v[160:161], v10 offset:20480
    ds_read_b64_tr_b16 v[162:163], v10 offset:20992
    v_mfma_f32_16x16x32_bf16 v[112:115], v[172:175], v[148:151], v[112:115]
    s_waitcnt lgkmcnt(8)
    v_mfma_f32_16x16x32_bf16 v[116:119], v[140:143], v[176:179], v[116:119]
    ds_read_b128 v[172:175], v15 offset:2048
    v_mfma_f32_16x16x32_bf16 v[120:123], v[144:147], v[176:179], v[120:123]
    v_mfma_f32_16x16x32_bf16 v[124:127], v[176:179], v[148:151], v[124:127]
    s_waitcnt lgkmcnt(6)
    v_mfma_f32_16x16x32_bf16 v[128:131], v[140:143], v[164:167], v[128:131]
    ds_read_b128 v[176:179], v15 offset:4096
    v_mfma_f32_16x16x32_bf16 v[132:135], v[144:147], v[164:167], v[132:135]
    v_mfma_f32_16x16x32_bf16 v[136:139], v[164:167], v[148:151], v[136:139]
    s_waitcnt lgkmcnt(2)
    v_mfma_f32_16x16x32_bf16 v[36:39], v[156:159], v[168:171], v[36:39]
    ds_read_b128 v[164:167], v15 offset:6144
    v_mfma_f32_16x16x32_bf16 v[40:43], v[168:171], v[160:163], v[40:43]
    s_waitcnt lgkmcnt(2)
    v_mfma_f32_16x16x32_bf16 v[44:47], v[152:155], v[172:175], v[44:47]
    ds_read_b128 v[168:171], v15 offset:8192
    v_mfma_f32_16x16x32_bf16 v[48:51], v[156:159], v[172:175], v[48:51]
    v_mfma_f32_16x16x32_bf16 v[52:55], v[172:175], v[160:163], v[52:55]
    s_waitcnt lgkmcnt(2)
    v_mfma_f32_16x16x32_bf16 v[56:59], v[152:155], v[176:179], v[56:59]
    ds_read_b128 v[172:175], v15 offset:10240
    v_mfma_f32_16x16x32_bf16 v[60:63], v[156:159], v[176:179], v[60:63]
    v_mfma_f32_16x16x32_bf16 v[64:67], v[176:179], v[160:163], v[64:67]
    s_waitcnt lgkmcnt(2)
    v_mfma_f32_16x16x32_bf16 v[68:71], v[152:155], v[164:167], v[68:71]
    ds_read_b128 v[176:179], v15 offset:12288
    v_mfma_f32_16x16x32_bf16 v[72:75], v[156:159], v[164:167], v[72:75]
    v_mfma_f32_16x16x32_bf16 v[76:79], v[164:167], v[160:163], v[76:79]
    s_barrier
    s_waitcnt lgkmcnt(2)
    v_mfma_f32_16x16x32_bf16 v[80:83], v[152:155], v[168:171], v[80:83]
    ds_read_b128 v[164:167], v15 offset:14336
    v_mfma_f32_16x16x32_bf16 v[84:87], v[156:159], v[168:171], v[84:87]
    ds_read_b64_tr_b16 v[140:141], v10 offset:24576
    ds_read_b64_tr_b16 v[142:143], v10 offset:25088
    v_mfma_f32_16x16x32_bf16 v[88:91], v[168:171], v[160:163], v[88:91]
    s_waitcnt lgkmcnt(4)
    v_mfma_f32_16x16x32_bf16 v[92:95], v[152:155], v[172:175], v[92:95]
    ds_read_b128 v[168:171], v15 offset:16384
    v_mfma_f32_16x16x32_bf16 v[96:99], v[156:159], v[172:175], v[96:99]
    ds_read_b64_tr_b16 v[144:145], v10 offset:28672
    ds_read_b64_tr_b16 v[146:147], v10 offset:29184
    v_mfma_f32_16x16x32_bf16 v[100:103], v[172:175], v[160:163], v[100:103]
    s_waitcnt lgkmcnt(6)
    v_mfma_f32_16x16x32_bf16 v[104:107], v[152:155], v[176:179], v[104:107]
    ds_read_b128 v[172:175], v14 offset:18432
    v_mfma_f32_16x16x32_bf16 v[108:111], v[156:159], v[176:179], v[108:111]
    ds_read_b64_tr_b16 v[148:149], v10 offset:32768
    ds_read_b64_tr_b16 v[150:151], v10 offset:33280
    v_mfma_f32_16x16x32_bf16 v[112:115], v[176:179], v[160:163], v[112:115]
    s_waitcnt lgkmcnt(8)
    v_mfma_f32_16x16x32_bf16 v[116:119], v[152:155], v[164:167], v[116:119]
    ds_read_b128 v[176:179], v14 offset:20480
    v_mfma_f32_16x16x32_bf16 v[120:123], v[156:159], v[164:167], v[120:123]
    v_mfma_f32_16x16x32_bf16 v[124:127], v[164:167], v[160:163], v[124:127]
    s_waitcnt lgkmcnt(6)
    v_mfma_f32_16x16x32_bf16 v[128:131], v[152:155], v[168:171], v[128:131]
    ds_read_b128 v[164:167], v14 offset:22528
    v_mfma_f32_16x16x32_bf16 v[132:135], v[156:159], v[168:171], v[132:135]
    v_mfma_f32_16x16x32_bf16 v[136:139], v[168:171], v[160:163], v[136:139]
    s_waitcnt lgkmcnt(2)
    v_mfma_f32_16x16x32_bf16 v[36:39], v[144:147], v[172:175], v[36:39]
    ds_read_b128 v[168:171], v14 offset:24576
    v_mfma_f32_16x16x32_bf16 v[40:43], v[172:175], v[148:151], v[40:43]
    s_waitcnt lgkmcnt(2)
    v_mfma_f32_16x16x32_bf16 v[44:47], v[140:143], v[176:179], v[44:47]
    ds_read_b128 v[172:175], v14 offset:26624
    v_mfma_f32_16x16x32_bf16 v[48:51], v[144:147], v[176:179], v[48:51]
    v_mfma_f32_16x16x32_bf16 v[52:55], v[176:179], v[148:151], v[52:55]
    s_waitcnt lgkmcnt(2)
    v_mfma_f32_16x16x32_bf16 v[56:59], v[140:143], v[164:167], v[56:59]
    ds_read_b128 v[176:179], v14 offset:28672
    v_mfma_f32_16x16x32_bf16 v[60:63], v[144:147], v[164:167], v[60:63]
    v_mfma_f32_16x16x32_bf16 v[64:67], v[164:167], v[148:151], v[64:67]
    s_waitcnt lgkmcnt(2)
    v_mfma_f32_16x16x32_bf16 v[68:71], v[140:143], v[168:171], v[68:71]
    ds_read_b128 v[164:167], v14 offset:30720
    v_mfma_f32_16x16x32_bf16 v[72:75], v[144:147], v[168:171], v[72:75]
    v_mfma_f32_16x16x32_bf16 v[76:79], v[168:171], v[148:151], v[76:79]
    s_barrier
    s_waitcnt lgkmcnt(2)
    v_mfma_f32_16x16x32_bf16 v[80:83], v[140:143], v[172:175], v[80:83]
    ds_read_b128 v[168:171], v14 offset:32768
    v_mfma_f32_16x16x32_bf16 v[84:87], v[144:147], v[172:175], v[84:87]
    ds_read_b64_tr_b16 v[152:153], v10 offset:36864
    ds_read_b64_tr_b16 v[154:155], v10 offset:37376
    v_mfma_f32_16x16x32_bf16 v[88:91], v[172:175], v[148:151], v[88:91]
    s_waitcnt lgkmcnt(4)
    v_mfma_f32_16x16x32_bf16 v[92:95], v[140:143], v[176:179], v[92:95]
    ds_read_b128 v[172:175], v14 offset:34816
    v_mfma_f32_16x16x32_bf16 v[96:99], v[144:147], v[176:179], v[96:99]
    ds_read_b64_tr_b16 v[156:157], v10 offset:40960
    ds_read_b64_tr_b16 v[158:159], v10 offset:41472
    v_mfma_f32_16x16x32_bf16 v[100:103], v[176:179], v[148:151], v[100:103]
    s_waitcnt lgkmcnt(6)
    v_mfma_f32_16x16x32_bf16 v[104:107], v[140:143], v[164:167], v[104:107]
    ds_read_b128 v[176:179], v15 offset:18432
    v_mfma_f32_16x16x32_bf16 v[108:111], v[144:147], v[164:167], v[108:111]
    ds_read_b64_tr_b16 v[160:161], v10 offset:45056
    ds_read_b64_tr_b16 v[162:163], v10 offset:45568
    v_mfma_f32_16x16x32_bf16 v[112:115], v[164:167], v[148:151], v[112:115]
    s_waitcnt lgkmcnt(8)
    v_mfma_f32_16x16x32_bf16 v[116:119], v[140:143], v[168:171], v[116:119]
    ds_read_b128 v[164:167], v15 offset:20480
    v_mfma_f32_16x16x32_bf16 v[120:123], v[144:147], v[168:171], v[120:123]
    v_mfma_f32_16x16x32_bf16 v[124:127], v[168:171], v[148:151], v[124:127]
    s_waitcnt lgkmcnt(6)
    v_mfma_f32_16x16x32_bf16 v[128:131], v[140:143], v[172:175], v[128:131]
    ds_read_b128 v[168:171], v15 offset:22528
    v_mfma_f32_16x16x32_bf16 v[132:135], v[144:147], v[172:175], v[132:135]
    v_mfma_f32_16x16x32_bf16 v[136:139], v[172:175], v[148:151], v[136:139]
    s_waitcnt lgkmcnt(2)
    v_mfma_f32_16x16x32_bf16 v[36:39], v[156:159], v[176:179], v[36:39]
    ds_read_b128 v[172:175], v15 offset:24576
    v_mfma_f32_16x16x32_bf16 v[40:43], v[176:179], v[160:163], v[40:43]
    s_waitcnt lgkmcnt(2)
    v_mfma_f32_16x16x32_bf16 v[44:47], v[152:155], v[164:167], v[44:47]
    ds_read_b128 v[176:179], v15 offset:26624
    v_mfma_f32_16x16x32_bf16 v[48:51], v[156:159], v[164:167], v[48:51]
    v_mfma_f32_16x16x32_bf16 v[52:55], v[164:167], v[160:163], v[52:55]
    s_waitcnt lgkmcnt(2)
    v_mfma_f32_16x16x32_bf16 v[56:59], v[152:155], v[168:171], v[56:59]
    ds_read_b128 v[164:167], v15 offset:28672
    v_mfma_f32_16x16x32_bf16 v[60:63], v[156:159], v[168:171], v[60:63]
    v_mfma_f32_16x16x32_bf16 v[64:67], v[168:171], v[160:163], v[64:67]
    s_waitcnt lgkmcnt(2)
    v_mfma_f32_16x16x32_bf16 v[68:71], v[152:155], v[172:175], v[68:71]
    ds_read_b128 v[168:171], v15 offset:30720
    v_mfma_f32_16x16x32_bf16 v[72:75], v[156:159], v[172:175], v[72:75]
    v_mfma_f32_16x16x32_bf16 v[76:79], v[172:175], v[160:163], v[76:79]
    s_waitcnt lgkmcnt(2)
    v_mfma_f32_16x16x32_bf16 v[80:83], v[152:155], v[176:179], v[80:83]
    ds_read_b128 v[172:175], v15 offset:32768
    v_mfma_f32_16x16x32_bf16 v[84:87], v[156:159], v[176:179], v[84:87]
    v_mfma_f32_16x16x32_bf16 v[88:91], v[176:179], v[160:163], v[88:91]
    s_waitcnt lgkmcnt(2)
    v_mfma_f32_16x16x32_bf16 v[92:95], v[152:155], v[164:167], v[92:95]
    ds_read_b128 v[176:179], v15 offset:34816
    v_mfma_f32_16x16x32_bf16 v[96:99], v[156:159], v[164:167], v[96:99]
    v_mfma_f32_16x16x32_bf16 v[100:103], v[164:167], v[160:163], v[100:103]
    s_waitcnt lgkmcnt(2)
    v_mfma_f32_16x16x32_bf16 v[104:107], v[152:155], v[168:171], v[104:107]
    v_mfma_f32_16x16x32_bf16 v[108:111], v[156:159], v[168:171], v[108:111]
    v_mfma_f32_16x16x32_bf16 v[112:115], v[168:171], v[160:163], v[112:115]
    s_waitcnt lgkmcnt(1)
    v_mfma_f32_16x16x32_bf16 v[116:119], v[152:155], v[172:175], v[116:119]
    v_mfma_f32_16x16x32_bf16 v[120:123], v[156:159], v[172:175], v[120:123]
    v_mfma_f32_16x16x32_bf16 v[124:127], v[172:175], v[160:163], v[124:127]
    s_waitcnt lgkmcnt(0)
    v_mfma_f32_16x16x32_bf16 v[128:131], v[152:155], v[176:179], v[128:131]
    v_mfma_f32_16x16x32_bf16 v[132:135], v[156:159], v[176:179], v[132:135]
    v_mfma_f32_16x16x32_bf16 v[136:139], v[176:179], v[160:163], v[136:139]
    s_barrier
    v_mov_b32 v4, 0
    global_load_dword v9, v4, s[28:29] sc1
    v_cvt_pk_bf16_f32 v36, v36, v37
    v_cvt_pk_bf16_f32 v37, v38, v39
    v_cvt_pk_bf16_f32 v180, v40, v41
    v_cvt_pk_bf16_f32 v181, v42, v43
    v_cvt_pk_bf16_f32 v200, v44, v45
    v_cvt_pk_bf16_f32 v201, v46, v47
    v_cvt_pk_bf16_f32 v48, v48, v49
    v_cvt_pk_bf16_f32 v49, v50, v51
    v_cvt_pk_bf16_f32 v182, v52, v53
    v_cvt_pk_bf16_f32 v183, v54, v55
    v_mfma_f32_16x16x16_bf16 v[202:205], v[48:49], v[200:201], 0
    v_mfma_f32_16x16x16_bf16 v[206:209], v[36:37], v[200:201], 0
    v_cvt_pk_bf16_f32 v226, v56, v57
    s_nop 5
    v_cndmask_b32 v202, v202, v203, s[42:43]
    v_cvt_pk_bf16_f32 v227, v58, v59
    v_cndmask_b32 v204, v204, v205, s[42:43]
    v_cvt_pk_bf16_f32 v60, v60, v61
    v_cndmask_b32 v206, v206, v207, s[42:43]
    v_cvt_pk_bf16_f32 v61, v62, v63
    v_cndmask_b32 v208, v208, v209, s[42:43]
    v_cvt_pk_bf16_f32 v184, v64, v65
    v_cndmask_b32 v222, v206, v202, s[44:45]
    v_cvt_pk_bf16_f32 v185, v66, v67
    v_cndmask_b32 v223, v208, v204, s[48:49]
    v_mfma_f32_16x16x16_bf16 v[228:231], v[60:61], v[226:227], 0
    v_add_f32 v222, v222, v24
    v_mfma_f32_16x16x16_bf16 v[232:235], v[48:49], v[226:227], 0
    v_add_f32 v223, v223, v25
    s_nop 4
    v_cndmask_b32 v228, v228, v229, s[42:43]
    v_max_f32 v224, v222, v223
    v_cndmask_b32 v230, v230, v231, s[42:43]
    v_mov_b32 v225, v224
    v_cndmask_b32 v232, v232, v233, s[42:43]
    s_nop 0
    v_permlane16_swap_b32 v224, v225
    v_cndmask_b32 v234, v234, v235, s[42:43]
    v_max_f32 v224, v224, v225
    v_cndmask_b32 v248, v232, v228, s[44:45]
    v_mov_b32 v225, v224
    v_cndmask_b32 v249, v234, v230, s[48:49]
    s_nop 0
    v_permlane32_swap_b32 v224, v225
    v_max_f32 v250, v248, v249
    v_max_f32 v224, v224, v225
    v_mov_b32 v251, v250
    v_mul_f32 v224, s50, v224
    s_nop 0
    v_permlane16_swap_b32 v250, v251
    v_fma_f32 v222, v222, s50, -v224
    v_max_f32 v250, v250, v251
    v_fma_f32 v223, v223, s50, -v224
    v_mov_b32 v251, v250
    v_exp_f32 v222, v222
    s_nop 0
    v_permlane32_swap_b32 v250, v251
    v_exp_f32 v223, v223
    v_max_f32 v250, v250, v251
    v_cvt_pk_bf16_f32 v222, v222, v222
    v_mul_f32 v250, s50, v250
    v_cvt_pk_bf16_f32 v223, v223, v223
    v_fma_f32 v248, v248, s50, -v250
    v_and_b32 v210, v222, v22
    v_fma_f32 v249, v249, s50, -v250
    v_and_b32 v211, v223, v23
    v_exp_f32 v248, v248
    v_and_b32 v212, v222, v20
    v_exp_f32 v249, v249
    v_and_b32 v213, v223, v21
    v_cvt_pk_bf16_f32 v248, v248, v248
    s_nop 0
    v_mfma_f32_16x16x32_bf16 v[218:221], v[26:29], v[210:213], 0
    v_cvt_pk_bf16_f32 v249, v249, v249
    v_mfma_f32_16x16x32_bf16 v[214:217], v[180:183], v[210:213], 0
    v_and_b32 v236, v248, v22
    s_nop 4
    v_rcp_f32 v218, v218
    v_and_b32 v237, v249, v23
    v_mul_f32 v214, v214, v218
    v_and_b32 v238, v248, v20
    v_mul_f32 v215, v215, v218
    v_and_b32 v239, v249, v21
    v_mul_f32 v216, v216, v218
    s_nop 0
    v_mfma_f32_16x16x32_bf16 v[244:247], v[26:29], v[236:239], 0
    v_mul_f32 v217, v217, v218
    v_mfma_f32_16x16x32_bf16 v[240:243], v[182:185], v[236:239], 0
    v_cvt_pk_bf16_f32 v140, v214, v215
    s_nop 4
    v_rcp_f32 v244, v244
    v_cvt_pk_bf16_f32 v141, v216, v217
    v_mul_f32 v240, v240, v244
    v_mul_f32 v241, v241, v244
    v_mul_f32 v242, v242, v244
    v_mul_f32 v243, v243, v244
    v_cvt_pk_bf16_f32 v142, v240, v241
    v_cvt_pk_bf16_f32 v143, v242, v243
    s_nop 0
    v_permlane16_swap_b32 v140, v142
    v_permlane16_swap_b32 v141, v143
    s_add_u32 s46, s51, 0
    buffer_store_dwordx4 v[140:143], v16, s[16:19], s46 offen sc1
    v_cvt_pk_bf16_f32 v200, v68, v69
    v_cvt_pk_bf16_f32 v201, v70, v71
    v_cvt_pk_bf16_f32 v72, v72, v73
    v_cvt_pk_bf16_f32 v73, v74, v75
    v_cvt_pk_bf16_f32 v186, v76, v77
    v_cvt_pk_bf16_f32 v187, v78, v79
    v_mfma_f32_16x16x16_bf16 v[202:205], v[72:73], v[200:201], 0
    v_mfma_f32_16x16x16_bf16 v[206:209], v[60:61], v[200:201], 0
    v_cvt_pk_bf16_f32 v226, v80, v81
    s_nop 5
    v_cndmask_b32 v202, v202, v203, s[42:43]
    v_cvt_pk_bf16_f32 v227, v82, v83
    v_cndmask_b32 v204, v204, v205, s[42:43]
    v_cvt_pk_bf16_f32 v84, v84, v85
    v_cndmask_b32 v206, v206, v207, s[42:43]
    v_cvt_pk_bf16_f32 v85, v86, v87
    v_cndmask_b32 v208, v208, v209, s[42:43]
    v_cvt_pk_bf16_f32 v188, v88, v89
    v_cndmask_b32 v222, v206, v202, s[44:45]
    v_cvt_pk_bf16_f32 v189, v90, v91
    v_cndmask_b32 v223, v208, v204, s[48:49]
    v_mfma_f32_16x16x16_bf16 v[228:231], v[84:85], v[226:227], 0
    v_max_f32 v224, v222, v223
    v_mfma_f32_16x16x16_bf16 v[232:235], v[72:73], v[226:227], 0
    v_mov_b32 v225, v224
    s_nop 4
    v_cndmask_b32 v228, v228, v229, s[42:43]
    v_permlane16_swap_b32 v224, v225
    v_cndmask_b32 v230, v230, v231, s[42:43]
    v_max_f32 v224, v224, v225
    v_cndmask_b32 v232, v232, v233, s[42:43]
    v_mov_b32 v225, v224
    v_cndmask_b32 v234, v234, v235, s[42:43]
    s_nop 0
    v_permlane32_swap_b32 v224, v225
    v_cndmask_b32 v248, v232, v228, s[44:45]
    v_max_f32 v224, v224, v225
    v_cndmask_b32 v249, v234, v230, s[48:49]
    v_mul_f32 v224, s50, v224
    v_max_f32 v250, v248, v249
    v_fma_f32 v222, v222, s50, -v224
    v_mov_b32 v251, v250
    v_fma_f32 v223, v223, s50, -v224
    s_nop 0
    v_permlane16_swap_b32 v250, v251
    v_exp_f32 v222, v222
    v_max_f32 v250, v250, v251
    v_exp_f32 v223, v223
    v_mov_b32 v251, v250
    v_cvt_pk_bf16_f32 v222, v222, v222
    s_nop 0
    v_permlane32_swap_b32 v250, v251
    v_cvt_pk_bf16_f32 v223, v223, v223
    v_max_f32 v250, v250, v251
    v_and_b32 v210, v222, v22
    v_mul_f32 v250, s50, v250
    v_and_b32 v211, v223, v23
    v_fma_f32 v248, v248, s50, -v250
    v_and_b32 v212, v222, v20
    v_fma_f32 v249, v249, s50, -v250
    v_and_b32 v213, v223, v21
    v_exp_f32 v248, v248
    s_nop 0
    v_mfma_f32_16x16x32_bf16 v[218:221], v[26:29], v[210:213], 0
    v_exp_f32 v249, v249
    v_mfma_f32_16x16x32_bf16 v[214:217], v[184:187], v[210:213], 0
    v_cvt_pk_bf16_f32 v248, v248, v248
    s_nop 4
    v_rcp_f32 v218, v218
    v_cvt_pk_bf16_f32 v249, v249, v249
    v_mul_f32 v214, v214, v218
    v_and_b32 v236, v248, v22
    v_mul_f32 v215, v215, v218
    v_and_b32 v237, v249, v23
    v_mul_f32 v216, v216, v218
    v_and_b32 v238, v248, v20
    v_mul_f32 v217, v217, v218
    v_and_b32 v239, v249, v21
    v_cvt_pk_bf16_f32 v144, v214, v215
    s_nop 0
    v_mfma_f32_16x16x32_bf16 v[244:247], v[26:29], v[236:239], 0
    v_cvt_pk_bf16_f32 v145, v216, v217
    v_mfma_f32_16x16x32_bf16 v[240:243], v[186:189], v[236:239], 0
    s_nop 5
    v_rcp_f32 v244, v244
    s_nop 0
    v_mul_f32 v240, v240, v244
    v_mul_f32 v241, v241, v244
    v_mul_f32 v242, v242, v244
    v_mul_f32 v243, v243, v244
    v_cvt_pk_bf16_f32 v146, v240, v241
    v_cvt_pk_bf16_f32 v147, v242, v243
    s_nop 0
    v_permlane16_swap_b32 v144, v146
    v_permlane16_swap_b32 v145, v147
    s_add_u32 s46, s51, 120832
    buffer_store_dwordx4 v[144:147], v16, s[16:19], s46 offen sc1
    v_cvt_pk_bf16_f32 v200, v92, v93
    v_cvt_pk_bf16_f32 v201, v94, v95
    v_cvt_pk_bf16_f32 v96, v96, v97
    v_cvt_pk_bf16_f32 v97, v98, v99
    v_cvt_pk_bf16_f32 v190, v100, v101
    v_cvt_pk_bf16_f32 v191, v102, v103
    v_mfma_f32_16x16x16_bf16 v[202:205], v[96:97], v[200:201], 0
    v_mfma_f32_16x16x16_bf16 v[206:209], v[84:85], v[200:201], 0
    v_cvt_pk_bf16_f32 v226, v104, v105
    s_nop 5
    v_cndmask_b32 v202, v202, v203, s[42:43]
    v_cvt_pk_bf16_f32 v227, v106, v107
    v_cndmask_b32 v204, v204, v205, s[42:43]
    v_cvt_pk_bf16_f32 v108, v108, v109
    v_cndmask_b32 v206, v206, v207, s[42:43]
    v_cvt_pk_bf16_f32 v109, v110, v111
    v_cndmask_b32 v208, v208, v209, s[42:43]
    v_cvt_pk_bf16_f32 v192, v112, v113
    v_cndmask_b32 v222, v206, v202, s[44:45]
    v_cvt_pk_bf16_f32 v193, v114, v115
    v_cndmask_b32 v223, v208, v204, s[48:49]
    v_mfma_f32_16x16x16_bf16 v[228:231], v[108:109], v[226:227], 0
    v_max_f32 v224, v222, v223
    v_mfma_f32_16x16x16_bf16 v[232:235], v[96:97], v[226:227], 0
    v_mov_b32 v225, v224
    s_nop 4
    v_cndmask_b32 v228, v228, v229, s[42:43]
    v_permlane16_swap_b32 v224, v225
    v_cndmask_b32 v230, v230, v231, s[42:43]
    v_max_f32 v224, v224, v225
    v_cndmask_b32 v232, v232, v233, s[42:43]
    v_mov_b32 v225, v224
    v_cndmask_b32 v234, v234, v235, s[42:43]
    s_nop 0
    v_permlane32_swap_b32 v224, v225
    v_cndmask_b32 v248, v232, v228, s[44:45]
    v_max_f32 v224, v224, v225
    v_cndmask_b32 v249, v234, v230, s[48:49]
    v_mul_f32 v224, s50, v224
    v_max_f32 v250, v248, v249
    v_fma_f32 v222, v222, s50, -v224
    v_mov_b32 v251, v250
    v_fma_f32 v223, v223, s50, -v224
    s_nop 0
    v_permlane16_swap_b32 v250, v251
    v_exp_f32 v222, v222
    v_max_f32 v250, v250, v251
    v_exp_f32 v223, v223
    v_mov_b32 v251, v250
    v_cvt_pk_bf16_f32 v222, v222, v222
    s_nop 0
    v_permlane32_swap_b32 v250, v251
    v_cvt_pk_bf16_f32 v223, v223, v223
    v_max_f32 v250, v250, v251
    v_and_b32 v210, v222, v22
    v_mul_f32 v250, s50, v250
    v_and_b32 v211, v223, v23
    v_fma_f32 v248, v248, s50, -v250
    v_and_b32 v212, v222, v20
    v_fma_f32 v249, v249, s50, -v250
    v_and_b32 v213, v223, v21
    v_exp_f32 v248, v248
    s_nop 0
    v_mfma_f32_16x16x32_bf16 v[218:221], v[26:29], v[210:213], 0
    v_exp_f32 v249, v249
    v_mfma_f32_16x16x32_bf16 v[214:217], v[188:191], v[210:213], 0
    v_cvt_pk_bf16_f32 v248, v248, v248
    s_nop 4
    v_rcp_f32 v218, v218
    v_cvt_pk_bf16_f32 v249, v249, v249
    v_mul_f32 v214, v214, v218
    v_and_b32 v236, v248, v22
    v_mul_f32 v215, v215, v218
    v_and_b32 v237, v249, v23
    v_mul_f32 v216, v216, v218
    v_and_b32 v238, v248, v20
    v_mul_f32 v217, v217, v218
    v_and_b32 v239, v249, v21
    v_cvt_pk_bf16_f32 v148, v214, v215
    s_nop 0
    v_mfma_f32_16x16x32_bf16 v[244:247], v[26:29], v[236:239], 0
    v_cvt_pk_bf16_f32 v149, v216, v217
    v_mfma_f32_16x16x32_bf16 v[240:243], v[190:193], v[236:239], 0
    s_nop 5
    v_rcp_f32 v244, v244
    s_nop 0
    v_mul_f32 v240, v240, v244
    v_mul_f32 v241, v241, v244
    v_mul_f32 v242, v242, v244
    v_mul_f32 v243, v243, v244
    v_cvt_pk_bf16_f32 v150, v240, v241
    v_cvt_pk_bf16_f32 v151, v242, v243
    s_nop 0
    v_permlane16_swap_b32 v148, v150
    v_permlane16_swap_b32 v149, v151
    s_add_u32 s46, s51, 241664
    buffer_store_dwordx4 v[148:151], v16, s[16:19], s46 offen sc1
    v_cvt_pk_bf16_f32 v200, v116, v117
    v_cvt_pk_bf16_f32 v201, v118, v119
    v_cvt_pk_bf16_f32 v120, v120, v121
    v_cvt_pk_bf16_f32 v121, v122, v123
    v_cvt_pk_bf16_f32 v194, v124, v125
    v_cvt_pk_bf16_f32 v195, v126, v127
    v_mfma_f32_16x16x16_bf16 v[202:205], v[120:121], v[200:201], 0
    v_mfma_f32_16x16x16_bf16 v[206:209], v[108:109], v[200:201], 0
    v_cvt_pk_bf16_f32 v226, v128, v129
    s_nop 5
    v_cndmask_b32 v202, v202, v203, s[42:43]
    v_cvt_pk_bf16_f32 v227, v130, v131
    v_cndmask_b32 v204, v204, v205, s[42:43]
    v_cvt_pk_bf16_f32 v132, v132, v133
    v_cndmask_b32 v206, v206, v207, s[42:43]
    v_cvt_pk_bf16_f32 v133, v134, v135
    v_cndmask_b32 v208, v208, v209, s[42:43]
    v_cvt_pk_bf16_f32 v196, v136, v137
    v_cndmask_b32 v222, v206, v202, s[44:45]
    v_cvt_pk_bf16_f32 v197, v138, v139
    v_cndmask_b32 v223, v208, v204, s[48:49]
    v_mfma_f32_16x16x16_bf16 v[228:231], v[132:133], v[226:227], 0
    v_max_f32 v224, v222, v223
    v_mfma_f32_16x16x16_bf16 v[232:235], v[120:121], v[226:227], 0
    v_mov_b32 v225, v224
    s_nop 4
    v_cndmask_b32 v228, v228, v229, s[42:43]
    v_permlane16_swap_b32 v224, v225
    v_cndmask_b32 v230, v230, v231, s[42:43]
    v_max_f32 v224, v224, v225
    v_cndmask_b32 v232, v232, v233, s[42:43]
    v_mov_b32 v225, v224
    v_cndmask_b32 v234, v234, v235, s[42:43]
    s_nop 0
    v_permlane32_swap_b32 v224, v225
    v_cndmask_b32 v248, v232, v228, s[44:45]
    v_max_f32 v224, v224, v225
    v_cndmask_b32 v249, v234, v230, s[48:49]
    v_mul_f32 v224, s50, v224
    v_max_f32 v250, v248, v249
    v_fma_f32 v222, v222, s50, -v224
    v_mov_b32 v251, v250
    v_fma_f32 v223, v223, s50, -v224
    s_nop 0
    v_permlane16_swap_b32 v250, v251
    v_exp_f32 v222, v222
    v_max_f32 v250, v250, v251
    v_exp_f32 v223, v223
    v_mov_b32 v251, v250
    v_cvt_pk_bf16_f32 v222, v222, v222
    s_nop 0
    v_permlane32_swap_b32 v250, v251
    v_cvt_pk_bf16_f32 v223, v223, v223
    v_max_f32 v250, v250, v251
    v_and_b32 v210, v222, v22
    v_mul_f32 v250, s50, v250
    v_and_b32 v211, v223, v23
    v_fma_f32 v248, v248, s50, -v250
    v_and_b32 v212, v222, v20
    v_fma_f32 v249, v249, s50, -v250
    v_and_b32 v213, v223, v21
    v_exp_f32 v248, v248
    s_nop 0
    v_mfma_f32_16x16x32_bf16 v[218:221], v[26:29], v[210:213], 0
    v_exp_f32 v249, v249
    v_mfma_f32_16x16x32_bf16 v[214:217], v[192:195], v[210:213], 0
    v_cvt_pk_bf16_f32 v248, v248, v248
    s_nop 4
    v_rcp_f32 v218, v218
    v_cvt_pk_bf16_f32 v249, v249, v249
    v_mul_f32 v214, v214, v218
    v_and_b32 v236, v248, v22
    v_mul_f32 v215, v215, v218
    v_and_b32 v237, v249, v23
    v_mul_f32 v216, v216, v218
    v_and_b32 v238, v248, v20
    v_mul_f32 v217, v217, v218
    v_and_b32 v239, v249, v21
    v_cvt_pk_bf16_f32 v152, v214, v215
    s_nop 0
    v_mfma_f32_16x16x32_bf16 v[244:247], v[26:29], v[236:239], 0
    v_cvt_pk_bf16_f32 v153, v216, v217
    v_mfma_f32_16x16x32_bf16 v[240:243], v[194:197], v[236:239], 0
    s_nop 5
    v_rcp_f32 v244, v244
    s_nop 0
    v_mul_f32 v240, v240, v244
    v_mul_f32 v241, v241, v244
    v_mul_f32 v242, v242, v244
    v_mul_f32 v243, v243, v244
    v_cvt_pk_bf16_f32 v154, v240, v241
    v_cvt_pk_bf16_f32 v155, v242, v243
    s_nop 0
    v_permlane16_swap_b32 v152, v154
    v_permlane16_swap_b32 v153, v155
    s_add_u32 s46, s51, 362496
    buffer_store_dwordx4 v[152:155], v16, s[16:19], s46 offen sc1
    s_branch L_fused_epidone
L_fused_ffn:
    s_waitcnt lgkmcnt(0)
    s_cmp_eq_u32 s3, 0
    s_cselect_b32 s12, s68, s76
    s_cselect_b32 s13, s69, s77
    s_mov_b32 s14, 0x158000
    s_cselect_b32 s14, 0x80000, s14
    s_mov_b32 s15, 0x20000
    s_mov_b32 s16, s84
    s_mov_b32 s17, s85
    s_mov_b32 s18, 0x800000
    s_mov_b32 s19, 0x20000
    s_mov_b32 s20, s80
    s_mov_b32 s21, s81
    s_mov_b32 s22, 0x200000
    s_mov_b32 s23, 0x20000
    s_mov_b32 s28, s82
    s_mov_b32 s29, s83
    s_mov_b32 s24, s74
    s_mov_b32 s25, s75
    s_mov_b32 s26, 2752
    s_mov_b32 s27, 0x20000
    s_and_b32 s38, s34, 7
    s_mul_i32 s38, s38, 12
    s_add_u32 s38, s38, s36
    s_lshl_b32 s46, s38, 5
    v_lshrrev_b32 v3, 4, v2
    v_lshlrev_b32 v3, 3, v3
    buffer_load_dwordx2 v[180:181], v3, s[24:27], s46 offen
    buffer_load_dwordx2 v[182:183], v3, s[24:27], s46 offen offset:128
    buffer_load_dwordx2 v[184:185], v3, s[24:27], s46 offen offset:256
    s_cmp_eq_u32 s36, 3
    s_cbranch_scc1 L_fused_tw321
    v_mul_u32_u24 v20, 3277, v2
    v_lshrrev_b32 v20, 16, v20
    v_mul_u32_u24 v21, 20, v20
    v_sub_u32 v21, v2, v21
    s_mul_i32 s38, s36, 3
    s_max_u32 s38, s38, 1
    v_add_u32 v20, s38, v20
    v_cmp_gt_u32 s[42:43], 8, v20
    s_cmp_eq_u32 s36, 0
    s_mov_b32 s39, 60
    s_cselect_b32 s39, 40, s39
    v_cmp_gt_u32 vcc, s39, v2
    s_nop 3
    s_and_b64 s[42:43], s[42:43], vcc
    s_lshl_b32 s38, s2, 13
    v_lshl_add_u32 v22, v21, 10, s38
    v_lshl_add_u32 v22, v20, 7, v22
    v_mov_b32 v24, s64
    v_mov_b32 v25, s65
    s_mul_i32 s38, s2, 768
    v_subrev_u32 v23, 8, v21
    v_lshl_add_u32 v23, v23, 7, s38
    v_mul_u32_u24 v26, 196608, v20
    v_add_u32 v23, v23, v26
    v_cmp_le_u32 vcc, 8, v21
    v_mov_b32 v26, s66
    v_mov_b32 v27, s67
    v_cndmask_b32 v22, v22, v23, vcc
    v_cndmask_b32 v24, v24, v26, vcc
    v_cndmask_b32 v25, v25, v27, vcc
    s_mul_i32 s38, s2, 688
    v_subrev_u32 v23, 14, v21
    v_lshl_add_u32 v23, v23, 7, s38
    v_min_u32 v23, 176124, v23
    v_mul_u32_u24 v26, 176128, v20
    v_add_u32 v23, v23, v26
    v_cmp_le_u32 vcc, 14, v21
    v_mov_b32 v26, s72
    v_mov_b32 v27, s73
    v_cndmask_b32 v22, v22, v23, vcc
    v_cndmask_b32 v24, v24, v26, vcc
    v_cndmask_b32 v25, v25, v27, vcc
    s_branch L_fused_tdone22
L_fused_tw321:
    s_lshl_b32 s38, s2, 11
    v_lshl_add_u32 v22, v2, 7, s38
    v_mov_b32 v24, s68
    v_mov_b32 v25, s69
    s_mul_i32 s38, s2, 5504
    v_subrev_u32 v23, 16, v2
    v_lshl_add_u32 v23, v23, 7, s38
    v_min_u32 v23, 0x157ffc, v23
    v_cmp_le_u32 vcc, 16, v2
    v_mov_b32 v26, s76
    v_mov_b32 v27, s77
    v_cndmask_b32 v22, v22, v23, vcc
    v_cndmask_b32 v24, v24, v26, vcc
    v_cndmask_b32 v25, v25, v27, vcc
    v_cmp_gt_u32 s[42:43], 59, v2
L_fused_tdone22:
    v_add_co_u32 v30, vcc, v24, v22
    s_nop 1
    v_addc_co_u32 v31, vcc, 0, v25, vcc
    s_nop 3
    s_mov_b64 s[54:55], s[42:43]
    s_mov_b32 s42, 1069066811
    s_and_b32 s38, s34, 7
    s_mul_i32 s38, s38, 12
    s_add_u32 s44, s38, s36
    s_mul_i32 s51, s33, 472
    s_add_u32 s51, s51, s44
    s_add_u32 s51, s51, 32
    s_lshl_b32 s51, s51, 10
    s_barrier
    ds_read_b64_tr_b16 v[140:141], v10 offset:0
    ds_read_b64_tr_b16 v[142:143], v10 offset:512
    ds_read_b64_tr_b16 v[144:145], v10 offset:4096
    ds_read_b64_tr_b16 v[146:147], v10 offset:4608
    ds_read_b64_tr_b16 v[148:149], v10 offset:8192
    ds_read_b64_tr_b16 v[150:151], v10 offset:8704
    ds_read_b128 v[164:167], v12 offset:2048
    ds_read_b128 v[168:171], v12 offset:4096
    ds_read_b128 v[172:175], v12 offset:6144
    s_waitcnt lgkmcnt(2)
    v_mfma_f32_16x16x32_bf16 v[44:47], v[140:143], v[164:167], 0
    ds_read_b128 v[176:179], v12 offset:8192
    v_mfma_f32_16x16x32_bf16 v[48:51], v[144:147], v[164:167], 0
    v_mfma_f32_16x16x32_bf16 v[52:55], v[148:151], v[164:167], 0
    s_waitcnt lgkmcnt(2)
    v_mfma_f32_16x16x32_bf16 v[56:59], v[140:143], v[168:171], 0
    ds_read_b128 v[164:167], v12 offset:10240
    v_mfma_f32_16x16x32_bf16 v[60:63], v[144:147], v[168:171], 0
    v_mfma_f32_16x16x32_bf16 v[64:67], v[148:151], v[168:171], 0
    s_waitcnt lgkmcnt(2)
    v_mfma_f32_16x16x32_bf16 v[68:71], v[140:143], v[172:175], 0
    ds_read_b128 v[168:171], v12 offset:12288
    v_mfma_f32_16x16x32_bf16 v[72:75], v[144:147], v[172:175], 0
    v_mfma_f32_16x16x32_bf16 v[76:79], v[148:151], v[172:175], 0
    s_waitcnt lgkmcnt(2)
    v_mfma_f32_16x16x32_bf16 v[80:83], v[140:143], v[176:179], 0
    ds_read_b128 v[172:175], v12 offset:14336
    v_mfma_f32_16x16x32_bf16 v[84:87], v[144:147], v[176:179], 0
    v_mfma_f32_16x16x32_bf16 v[88:91], v[148:151], v[176:179], 0
    s_barrier
    s_lshr_b32 s38, 8, s36
    s_bitcmp1_b32 s38, 0
    s_cbranch_scc0 L_fused_noti23
    s_mov_b64 exec, s[54:55]
    global_load_dword v19, v[30:31], off
    s_mov_b64 exec, -1
L_fused_noti23:
    s_waitcnt lgkmcnt(2)
    v_mfma_f32_16x16x32_bf16 v[92:95], v[140:143], v[164:167], 0
    ds_read_b128 v[176:179], v12 offset:16384
    v_mfma_f32_16x16x32_bf16 v[96:99], v[144:147], v[164:167], 0
    ds_read_b64_tr_b16 v[152:153], v10 offset:12288
    ds_read_b64_tr_b16 v[154:155], v10 offset:12800
    v_mfma_f32_16x16x32_bf16 v[100:103], v[148:151], v[164:167], 0
    s_waitcnt lgkmcnt(4)
    v_mfma_f32_16x16x32_bf16 v[104:107], v[140:143], v[168:171], 0
    ds_read_b128 v[164:167], v13 offset:2048
    v_mfma_f32_16x16x32_bf16 v[108:111], v[144:147], v[168:171], 0
    ds_read_b64_tr_b16 v[156:157], v10 offset:16384
    ds_read_b64_tr_b16 v[158:159], v10 offset:16896
    v_mfma_f32_16x16x32_bf16 v[112:115], v[148:151], v[168:171], 0
    s_waitcnt lgkmcnt(6)
    v_mfma_f32_16x16x32_bf16 v[116:119], v[140:143], v[172:175], 0
    ds_read_b128 v[168:171], v13 offset:4096
    v_mfma_f32_16x16x32_bf16 v[120:123], v[144:147], v[172:175], 0
    ds_read_b64_tr_b16 v[160:161], v10 offset:20480
    ds_read_b64_tr_b16 v[162:163], v10 offset:20992
    v_mfma_f32_16x16x32_bf16 v[124:127], v[148:151], v[172:175], 0
    s_waitcnt lgkmcnt(8)
    v_mfma_f32_16x16x32_bf16 v[128:131], v[140:143], v[176:179], 0
    ds_read_b128 v[172:175], v13 offset:6144
    v_mfma_f32_16x16x32_bf16 v[132:135], v[144:147], v[176:179], 0
    v_mfma_f32_16x16x32_bf16 v[136:139], v[148:151], v[176:179], 0
    s_waitcnt lgkmcnt(1)
    v_mfma_f32_16x16x32_bf16 v[44:47], v[152:155], v[164:167], v[44:47]
    ds_read_b128 v[176:179], v13 offset:8192
    v_mfma_f32_16x16x32_bf16 v[48:51], v[156:159], v[164:167], v[48:51]
    v_mfma_f32_16x16x32_bf16 v[52:55], v[160:163], v[164:167], v[52:55]
    v_mfma_f32_16x16x32_bf16 v[56:59], v[152:155], v[168:171], v[56:59]
    ds_read_b128 v[164:167], v13 offset:10240
    v_mfma_f32_16x16x32_bf16 v[60:63], v[156:159], v[168:171], v[60:63]
    v_mfma_f32_16x16x32_bf16 v[64:67], v[160:163], v[168:171], v[64:67]
    s_waitcnt lgkmcnt(2)
    v_mfma_f32_16x16x32_bf16 v[68:71], v[152:155], v[172:175], v[68:71]
    ds_read_b128 v[168:171], v13 offset:12288
    v_mfma_f32_16x16x32_bf16 v[72:75], v[156:159], v[172:175], v[72:75]
    v_mfma_f32_16x16x32_bf16 v[76:79], v[160:163], v[172:175], v[76:79]
    s_waitcnt lgkmcnt(2)
    v_mfma_f32_16x16x32_bf16 v[80:83], v[152:155], v[176:179], v[80:83]
    ds_read_b128 v[172:175], v13 offset:14336
    v_mfma_f32_16x16x32_bf16 v[84:87], v[156:159], v[176:179], v[84:87]
    v_mfma_f32_16x16x32_bf16 v[88:91], v[160:163], v[176:179], v[88:91]
    s_barrier
    s_waitcnt lgkmcnt(2)
    v_mfma_f32_16x16x32_bf16 v[92:95], v[152:155], v[164:167], v[92:95]
    ds_read_b128 v[176:179], v13 offset:16384
    v_mfma_f32_16x16x32_bf16 v[96:99], v[156:159], v[164:167], v[96:99]
    ds_read_b64_tr_b16 v[140:141], v10 offset:24576
    ds_read_b64_tr_b16 v[142:143], v10 offset:25088
    v_mfma_f32_16x16x32_bf16 v[100:103], v[160:163], v[164:167], v[100:103]
    s_waitcnt lgkmcnt(4)
    v_mfma_f32_16x16x32_bf16 v[104:107], v[152:155], v[168:171], v[104:107]
    ds_read_b128 v[164:167], v12 offset:20480
    v_mfma_f32_16x16x32_bf16 v[108:111], v[156:159], v[168:171], v[108:111]
    ds_read_b64_tr_b16 v[144:145], v10 offset:28672
    ds_read_b64_tr_b16 v[146:147], v10 offset:29184
    v_mfma_f32_16x16x32_bf16 v[112:115], v[160:163], v[168:171], v[112:115]
    s_waitcnt lgkmcnt(6)
    v_mfma_f32_16x16x32_bf16 v[116:119], v[152:155], v[172:175], v[116:119]
    ds_read_b128 v[168:171], v12 offset:22528
    v_mfma_f32_16x16x32_bf16 v[120:123], v[156:159], v[172:175], v[120:123]
    ds_read_b64_tr_b16 v[148:149], v10 offset:32768
    ds_read_b64_tr_b16 v[150:151], v10 offset:33280
    v_mfma_f32_16x16x32_bf16 v[124:127], v[160:163], v[172:175], v[124:127]
    s_waitcnt lgkmcnt(8)
    v_mfma_f32_16x16x32_bf16 v[128:131], v[152:155], v[176:179], v[128:131]
    ds_read_b128 v[172:175], v12 offset:24576
    v_mfma_f32_16x16x32_bf16 v[132:135], v[156:159], v[176:179], v[132:135]
    v_mfma_f32_16x16x32_bf16 v[136:139], v[160:163], v[176:179], v[136:139]
    s_waitcnt lgkmcnt(1)
    v_mfma_f32_16x16x32_bf16 v[44:47], v[140:143], v[164:167], v[44:47]
    ds_read_b128 v[176:179], v12 offset:26624
    v_mfma_f32_16x16x32_bf16 v[48:51], v[144:147], v[164:167], v[48:51]
    v_mfma_f32_16x16x32_bf16 v[52:55], v[148:151], v[164:167], v[52:55]
    v_mfma_f32_16x16x32_bf16 v[56:59], v[140:143], v[168:171], v[56:59]
    ds_read_b128 v[164:167], v12 offset:28672
    v_mfma_f32_16x16x32_bf16 v[60:63], v[144:147], v[168:171], v[60:63]
    v_mfma_f32_16x16x32_bf16 v[64:67], v[148:151], v[168:171], v[64:67]
    s_waitcnt lgkmcnt(2)
    v_mfma_f32_16x16x32_bf16 v[68:71], v[140:143], v[172:175], v[68:71]
    ds_read_b128 v[168:171], v12 offset:30720
    v_mfma_f32_16x16x32_bf16 v[72:75], v[144:147], v[172:175], v[72:75]
    v_mfma_f32_16x16x32_bf16 v[76:79], v[148:151], v[172:175], v[76:79]
    s_waitcnt lgkmcnt(2)
    v_mfma_f32_16x16x32_bf16 v[80:83], v[140:143], v[176:179], v[80:83]
    ds_read_b128 v[172:175], v12 offset:32768
    v_mfma_f32_16x16x32_bf16 v[84:87], v[144:147], v[176:179], v[84:87]
    v_mfma_f32_16x16x32_bf16 v[88:91], v[148:151], v[176:179], v[88:91]
    s_barrier
    s_cmp_lg_u32 s30, 3
    s_cbranch_scc1 L_fused_nfw24
    s_lshl_b32 s38, s40, 3
    s_add_u32 s38, s38, s41
    s_lshl_b32 s38, s38, 7
    s_add_u32 s46, s38, 7929856
    v_mov_b32 v4, 0
    s_mov_b64 exec, 1
    buffer_load_dword v19, v4, s[16:19], s46 offen sc1
    s_mov_b64 exec, -1
L_fused_nfw24:
    s_waitcnt lgkmcnt(2)
    v_mfma_f32_16x16x32_bf16 v[92:95], v[140:143], v[164:167], v[92:95]
    ds_read_b128 v[176:179], v12 offset:34816
    v_mfma_f32_16x16x32_bf16 v[96:99], v[144:147], v[164:167], v[96:99]
    ds_read_b64_tr_b16 v[152:153], v10 offset:36864
    ds_read_b64_tr_b16 v[154:155], v10 offset:37376
    v_mfma_f32_16x16x32_bf16 v[100:103], v[148:151], v[164:167], v[100:103]
    s_waitcnt lgkmcnt(4)
    v_mfma_f32_16x16x32_bf16 v[104:107], v[140:143], v[168:171], v[104:107]
    ds_read_b128 v[164:167], v13 offset:20480
    v_mfma_f32_16x16x32_bf16 v[108:111], v[144:147], v[168:171], v[108:111]
    ds_read_b64_tr_b16 v[156:157], v10 offset:40960
    ds_read_b64_tr_b16 v[158:159], v10 offset:41472
    v_mfma_f32_16x16x32_bf16 v[112:115], v[148:151], v[168:171], v[112:115]
    s_waitcnt lgkmcnt(6)
    v_mfma_f32_16x16x32_bf16 v[116:119], v[140:143], v[172:175], v[116:119]
    ds_read_b128 v[168:171], v13 offset:22528
    v_mfma_f32_16x16x32_bf16 v[120:123], v[144:147], v[172:175], v[120:123]
    ds_read_b64_tr_b16 v[160:161], v10 offset:45056
    ds_read_b64_tr_b16 v[162:163], v10 offset:45568
    v_mfma_f32_16x16x32_bf16 v[124:127], v[148:151], v[172:175], v[124:127]
    s_waitcnt lgkmcnt(8)
    v_mfma_f32_16x16x32_bf16 v[128:131], v[140:143], v[176:179], v[128:131]
    ds_read_b128 v[172:175], v13 offset:24576
    v_mfma_f32_16x16x32_bf16 v[132:135], v[144:147], v[176:179], v[132:135]
    v_mfma_f32_16x16x32_bf16 v[136:139], v[148:151], v[176:179], v[136:139]
    s_waitcnt lgkmcnt(1)
    v_mfma_f32_16x16x32_bf16 v[44:47], v[152:155], v[164:167], v[44:47]
    ds_read_b128 v[176:179], v13 offset:26624
    v_mfma_f32_16x16x32_bf16 v[48:51], v[156:159], v[164:167], v[48:51]
    v_mfma_f32_16x16x32_bf16 v[52:55], v[160:163], v[164:167], v[52:55]
    v_mfma_f32_16x16x32_bf16 v[56:59], v[152:155], v[168:171], v[56:59]
    ds_read_b128 v[164:167], v13 offset:28672
    v_mfma_f32_16x16x32_bf16 v[60:63], v[156:159], v[168:171], v[60:63]
    v_mfma_f32_16x16x32_bf16 v[64:67], v[160:163], v[168:171], v[64:67]
    s_waitcnt lgkmcnt(2)
    v_mfma_f32_16x16x32_bf16 v[68:71], v[152:155], v[172:175], v[68:71]
    ds_read_b128 v[168:171], v13 offset:30720
    v_mfma_f32_16x16x32_bf16 v[72:75], v[156:159], v[172:175], v[72:75]
    v_mfma_f32_16x16x32_bf16 v[76:79], v[160:163], v[172:175], v[76:79]
    s_waitcnt lgkmcnt(2)
    v_mfma_f32_16x16x32_bf16 v[80:83], v[152:155], v[176:179], v[80:83]
    ds_read_b128 v[172:175], v13 offset:32768
    v_mfma_f32_16x16x32_bf16 v[84:87], v[156:159], v[176:179], v[84:87]
    v_mfma_f32_16x16x32_bf16 v[88:91], v[160:163], v[176:179], v[88:91]
    s_barrier
    s_waitcnt lgkmcnt(2)
    v_mfma_f32_16x16x32_bf16 v[92:95], v[152:155], v[164:167], v[92:95]
    ds_read_b128 v[176:179], v13 offset:34816
    v_mfma_f32_16x16x32_bf16 v[96:99], v[156:159], v[164:167], v[96:99]
    ds_read_b64_tr_b16 v[140:141], v10 offset:49152
    ds_read_b64_tr_b16 v[142:143], v10 offset:49664
    v_mfma_f32_16x16x32_bf16 v[100:103], v[160:163], v[164:167], v[100:103]
    s_waitcnt lgkmcnt(4)
    v_mfma_f32_16x16x32_bf16 v[104:107], v[152:155], v[168:171], v[104:107]
    ds_read_b128 v[164:167], v14 offset:2048
    v_mfma_f32_16x16x32_bf16 v[108:111], v[156:159], v[168:171], v[108:111]
    ds_read_b64_tr_b16 v[144:145], v10 offset:53248
    ds_read_b64_tr_b16 v[146:147], v10 offset:53760
    v_mfma_f32_16x16x32_bf16 v[112:115], v[160:163], v[168:171], v[112:115]
    s_waitcnt lgkmcnt(6)
    v_mfma_f32_16x16x32_bf16 v[116:119], v[152:155], v[172:175], v[116:119]
    ds_read_b128 v[168:171], v14 offset:4096
    v_mfma_f32_16x16x32_bf16 v[120:123], v[156:159], v[172:175], v[120:123]
    ds_read_b64_tr_b16 v[148:149], v10 offset:57344
    ds_read_b64_tr_b16 v[150:151], v10 offset:57856
    v_mfma_f32_16x16x32_bf16 v[124:127], v[160:163], v[172:175], v[124:127]
    s_waitcnt lgkmcnt(8)
    v_mfma_f32_16x16x32_bf16 v[128:131], v[152:155], v[176:179], v[128:131]
    ds_read_b128 v[172:175], v14 offset:6144
    v_mfma_f32_16x16x32_bf16 v[132:135], v[156:159], v[176:179], v[132:135]
    v_mfma_f32_16x16x32_bf16 v[136:139], v[160:163], v[176:179], v[136:139]
    s_waitcnt lgkmcnt(1)
    v_mfma_f32_16x16x32_bf16 v[44:47], v[140:143], v[164:167], v[44:47]
    ds_read_b128 v[176:179], v14 offset:8192
    v_mfma_f32_16x16x32_bf16 v[48:51], v[144:147], v[164:167], v[48:51]
    v_mfma_f32_16x16x32_bf16 v[52:55], v[148:151], v[164:167], v[52:55]
    v_mfma_f32_16x16x32_bf16 v[56:59], v[140:143], v[168:171], v[56:59]
    ds_read_b128 v[164:167], v14 offset:10240
    v_mfma_f32_16x16x32_bf16 v[60:63], v[144:147], v[168:171], v[60:63]
    v_mfma_f32_16x16x32_bf16 v[64:67], v[148:151], v[168:171], v[64:67]
    s_waitcnt lgkmcnt(2)
    v_mfma_f32_16x16x32_bf16 v[68:71], v[140:143], v[172:175], v[68:71]
    ds_read_b128 v[168:171], v14 offset:12288
    v_mfma_f32_16x16x32_bf16 v[72:75], v[144:147], v[172:175], v[72:75]
    v_mfma_f32_16x16x32_bf16 v[76:79], v[148:151], v[172:175], v[76:79]
    s_waitcnt lgkmcnt(2)
    v_mfma_f32_16x16x32_bf16 v[80:83], v[140:143], v[176:179], v[80:83]
    ds_read_b128 v[172:175], v14 offset:14336
    v_mfma_f32_16x16x32_bf16 v[84:87], v[144:147], v[176:179], v[84:87]
    v_mfma_f32_16x16x32_bf16 v[88:91], v[148:151], v[176:179], v[88:91]
    s_barrier
    s_waitcnt lgkmcnt(2)
    v_mfma_f32_16x16x32_bf16 v[92:95], v[140:143], v[164:167], v[92:95]
    ds_read_b128 v[176:179], v14 offset:16384
    v_mfma_f32_16x16x32_bf16 v[96:99], v[144:147], v[164:167], v[96:99]
    ds_read_b64_tr_b16 v[152:153], v11 offset:0
    ds_read_b64_tr_b16 v[154:155], v11 offset:512
    v_mfma_f32_16x16x32_bf16 v[100:103], v[148:151], v[164:167], v[100:103]
    s_waitcnt lgkmcnt(4)
    v_mfma_f32_16x16x32_bf16 v[104:107], v[140:143], v[168:171], v[104:107]
    ds_read_b128 v[164:167], v15 offset:2048
    v_mfma_f32_16x16x32_bf16 v[108:111], v[144:147], v[168:171], v[108:111]
    ds_read_b64_tr_b16 v[156:157], v11 offset:4096
    ds_read_b64_tr_b16 v[158:159], v11 offset:4608
    v_mfma_f32_16x16x32_bf16 v[112:115], v[148:151], v[168:171], v[112:115]
    s_waitcnt lgkmcnt(6)
    v_mfma_f32_16x16x32_bf16 v[116:119], v[140:143], v[172:175], v[116:119]
    ds_read_b128 v[168:171], v15 offset:4096
    v_mfma_f32_16x16x32_bf16 v[120:123], v[144:147], v[172:175], v[120:123]
    ds_read_b64_tr_b16 v[160:161], v11 offset:8192
    ds_read_b64_tr_b16 v[162:163], v11 offset:8704
    v_mfma_f32_16x16x32_bf16 v[124:127], v[148:151], v[172:175], v[124:127]
    s_waitcnt lgkmcnt(8)
    v_mfma_f32_16x16x32_bf16 v[128:131], v[140:143], v[176:179], v[128:131]
    ds_read_b128 v[172:175], v15 offset:6144
    v_mfma_f32_16x16x32_bf16 v[132:135], v[144:147], v[176:179], v[132:135]
    v_mfma_f32_16x16x32_bf16 v[136:139], v[148:151], v[176:179], v[136:139]
    s_waitcnt lgkmcnt(1)
    v_mfma_f32_16x16x32_bf16 v[44:47], v[152:155], v[164:167], v[44:47]
    ds_read_b128 v[176:179], v15 offset:8192
    v_mfma_f32_16x16x32_bf16 v[48:51], v[156:159], v[164:167], v[48:51]
    v_mfma_f32_16x16x32_bf16 v[52:55], v[160:163], v[164:167], v[52:55]
    v_mfma_f32_16x16x32_bf16 v[56:59], v[152:155], v[168:171], v[56:59]
    ds_read_b128 v[164:167], v15 offset:10240
    v_mfma_f32_16x16x32_bf16 v[60:63], v[156:159], v[168:171], v[60:63]
    v_mfma_f32_16x16x32_bf16 v[64:67], v[160:163], v[168:171], v[64:67]
    s_waitcnt lgkmcnt(2)
    v_mfma_f32_16x16x32_bf16 v[68:71], v[152:155], v[172:175], v[68:71]
    ds_read_b128 v[168:171], v15 offset:12288
    v_mfma_f32_16x16x32_bf16 v[72:75], v[156:159], v[172:175], v[72:75]
    v_mfma_f32_16x16x32_bf16 v[76:79], v[160:163], v[172:175], v[76:79]
    s_waitcnt lgkmcnt(2)
    v_mfma_f32_16x16x32_bf16 v[80:83], v[152:155], v[176:179], v[80:83]
    ds_read_b128 v[172:175], v15 offset:14336
    v_mfma_f32_16x16x32_bf16 v[84:87], v[156:159], v[176:179], v[84:87]
    v_mfma_f32_16x16x32_bf16 v[88:91], v[160:163], v[176:179], v[88:91]
    s_barrier
    s_waitcnt lgkmcnt(2)
    v_mfma_f32_16x16x32_bf16 v[92:95], v[152:155], v[164:167], v[92:95]
    ds_read_b128 v[176:179], v15 offset:16384
    v_mfma_f32_16x16x32_bf16 v[96:99], v[156:159], v[164:167], v[96:99]
    ds_read_b64_tr_b16 v[140:141], v10 offset:0
    ds_read_b64_tr_b16 v[142:143], v10 offset:512
    v_mfma_f32_16x16x32_bf16 v[100:103], v[160:163], v[164:167], v[100:103]
    s_waitcnt lgkmcnt(4)
    v_mfma_f32_16x16x32_bf16 v[104:107], v[152:155], v[168:171], v[104:107]
    ds_read_b128 v[164:167], v14 offset:20480
    v_mfma_f32_16x16x32_bf16 v[108:111], v[156:159], v[168:171], v[108:111]
    ds_read_b64_tr_b16 v[144:145], v10 offset:4096
    ds_read_b64_tr_b16 v[146:147], v10 offset:4608
    v_mfma_f32_16x16x32_bf16 v[112:115], v[160:163], v[168:171], v[112:115]
    s_waitcnt lgkmcnt(6)
    v_mfma_f32_16x16x32_bf16 v[116:119], v[152:155], v[172:175], v[116:119]
    ds_read_b128 v[168:171], v14 offset:22528
    v_mfma_f32_16x16x32_bf16 v[120:123], v[156:159], v[172:175], v[120:123]
    ds_read_b64_tr_b16 v[148:149], v10 offset:8192
    ds_read_b64_tr_b16 v[150:151], v10 offset:8704
    v_mfma_f32_16x16x32_bf16 v[124:127], v[160:163], v[172:175], v[124:127]
    s_waitcnt lgkmcnt(8)
    v_mfma_f32_16x16x32_bf16 v[128:131], v[152:155], v[176:179], v[128:131]
    ds_read_b128 v[172:175], v14 offset:24576
    v_mfma_f32_16x16x32_bf16 v[132:135], v[156:159], v[176:179], v[132:135]
    v_mfma_f32_16x16x32_bf16 v[136:139], v[160:163], v[176:179], v[136:139]
    s_waitcnt lgkmcnt(1)
    v_mfma_f32_16x16x32_bf16 v[44:47], v[140:143], v[164:167], v[44:47]
    ds_read_b128 v[176:179], v14 offset:26624
    v_mfma_f32_16x16x32_bf16 v[48:51], v[144:147], v[164:167], v[48:51]
    v_mfma_f32_16x16x32_bf16 v[52:55], v[148:151], v[164:167], v[52:55]
    v_mfma_f32_16x16x32_bf16 v[56:59], v[140:143], v[168:171], v[56:59]
    ds_read_b128 v[164:167], v14 offset:28672
    v_mfma_f32_16x16x32_bf16 v[60:63], v[144:147], v[168:171], v[60:63]
    v_mfma_f32_16x16x32_bf16 v[64:67], v[148:151], v[168:171], v[64:67]
    s_waitcnt lgkmcnt(2)
    v_mfma_f32_16x16x32_bf16 v[68:71], v[140:143], v[172:175], v[68:71]
    ds_read_b128 v[168:171], v14 offset:30720
    v_mfma_f32_16x16x32_bf16 v[72:75], v[144:147], v[172:175], v[72:75]
    v_mfma_f32_16x16x32_bf16 v[76:79], v[148:151], v[172:175], v[76:79]
    s_waitcnt lgkmcnt(2)
    v_mfma_f32_16x16x32_bf16 v[80:83], v[140:143], v[176:179], v[80:83]
    ds_read_b128 v[172:175], v14 offset:32768
    v_mfma_f32_16x16x32_bf16 v[84:87], v[144:147], v[176:179], v[84:87]
    v_mfma_f32_16x16x32_bf16 v[88:91], v[148:151], v[176:179], v[88:91]
    s_barrier
    s_waitcnt lgkmcnt(2)
    v_mfma_f32_16x16x32_bf16 v[92:95], v[140:143], v[164:167], v[92:95]
    ds_read_b128 v[176:179], v14 offset:34816
    v_mfma_f32_16x16x32_bf16 v[96:99], v[144:147], v[164:167], v[96:99]
    ds_read_b64_tr_b16 v[152:153], v10 offset:12288
    ds_read_b64_tr_b16 v[154:155], v10 offset:12800
    v_mfma_f32_16x16x32_bf16 v[100:103], v[148:151], v[164:167], v[100:103]
    s_waitcnt lgkmcnt(4)
    v_mfma_f32_16x16x32_bf16 v[104:107], v[140:143], v[168:171], v[104:107]
    ds_read_b128 v[164:167], v15 offset:20480
    v_mfma_f32_16x16x32_bf16 v[108:111], v[144:147], v[168:171], v[108:111]
    ds_read_b64_tr_b16 v[156:157], v10 offset:16384
    ds_read_b64_tr_b16 v[158:159], v10 offset:16896
    v_mfma_f32_16x16x32_bf16 v[112:115], v[148:151], v[168:171], v[112:115]
    s_waitcnt lgkmcnt(6)
    v_mfma_f32_16x16x32_bf16 v[116:119], v[140:143], v[172:175], v[116:119]
    ds_read_b128 v[168:171], v15 offset:22528
    v_mfma_f32_16x16x32_bf16 v[120:123], v[144:147], v[172:175], v[120:123]
    ds_read_b64_tr_b16 v[160:161], v10 offset:20480
    ds_read_b64_tr_b16 v[162:163], v10 offset:20992
    v_mfma_f32_16x16x32_bf16 v[124:127], v[148:151], v[172:175], v[124:127]
    s_waitcnt lgkmcnt(8)
    v_mfma_f32_16x16x32_bf16 v[128:131], v[140:143], v[176:179], v[128:131]
    ds_read_b128 v[172:175], v15 offset:24576
    v_mfma_f32_16x16x32_bf16 v[132:135], v[144:147], v[176:179], v[132:135]
    v_mfma_f32_16x16x32_bf16 v[136:139], v[148:151], v[176:179], v[136:139]
    s_waitcnt lgkmcnt(1)
    v_mfma_f32_16x16x32_bf16 v[44:47], v[152:155], v[164:167], v[44:47]
    ds_read_b128 v[176:179], v15 offset:26624
    v_mfma_f32_16x16x32_bf16 v[48:51], v[156:159], v[164:167], v[48:51]
    v_mfma_f32_16x16x32_bf16 v[52:55], v[160:163], v[164:167], v[52:55]
    v_mfma_f32_16x16x32_bf16 v[56:59], v[152:155], v[168:171], v[56:59]
    ds_read_b128 v[164:167], v15 offset:28672
    v_mfma_f32_16x16x32_bf16 v[60:63], v[156:159], v[168:171], v[60:63]
    v_mfma_f32_16x16x32_bf16 v[64:67], v[160:163], v[168:171], v[64:67]
    s_waitcnt lgkmcnt(2)
    v_mfma_f32_16x16x32_bf16 v[68:71], v[152:155], v[172:175], v[68:71]
    ds_read_b128 v[168:171], v15 offset:30720
    v_mfma_f32_16x16x32_bf16 v[72:75], v[156:159], v[172:175], v[72:75]
    v_mfma_f32_16x16x32_bf16 v[76:79], v[160:163], v[172:175], v[76:79]
    s_waitcnt lgkmcnt(2)
    v_mfma_f32_16x16x32_bf16 v[80:83], v[152:155], v[176:179], v[80:83]
    ds_read_b128 v[172:175], v15 offset:32768
    v_mfma_f32_16x16x32_bf16 v[84:87], v[156:159], v[176:179], v[84:87]
    v_mfma_f32_16x16x32_bf16 v[88:91], v[160:163], v[176:179], v[88:91]
    s_barrier
    s_waitcnt lgkmcnt(2)
    v_mfma_f32_16x16x32_bf16 v[92:95], v[152:155], v[164:167], v[92:95]
    ds_read_b128 v[176:179], v15 offset:34816
    v_mfma_f32_16x16x32_bf16 v[96:99], v[156:159], v[164:167], v[96:99]
    ds_read_b64_tr_b16 v[140:141], v10 offset:24576
    ds_read_b64_tr_b16 v[142:143], v10 offset:25088
    v_mfma_f32_16x16x32_bf16 v[100:103], v[160:163], v[164:167], v[100:103]
    s_waitcnt lgkmcnt(4)
    v_mfma_f32_16x16x32_bf16 v[104:107], v[152:155], v[168:171], v[104:107]
    ds_read_b128 v[164:167], v12 offset:2048
    v_mfma_f32_16x16x32_bf16 v[108:111], v[156:159], v[168:171], v[108:111]
    ds_read_b64_tr_b16 v[144:145], v10 offset:28672
    ds_read_b64_tr_b16 v[146:147], v10 offset:29184
    v_mfma_f32_16x16x32_bf16 v[112:115], v[160:163], v[168:171], v[112:115]
    s_waitcnt lgkmcnt(6)
    v_mfma_f32_16x16x32_bf16 v[116:119], v[152:155], v[172:175], v[116:119]
    ds_read_b128 v[168:171], v12 offset:4096
    v_mfma_f32_16x16x32_bf16 v[120:123], v[156:159], v[172:175], v[120:123]
    ds_read_b64_tr_b16 v[148:149], v10 offset:32768
    ds_read_b64_tr_b16 v[150:151], v10 offset:33280
    v_mfma_f32_16x16x32_bf16 v[124:127], v[160:163], v[172:175], v[124:127]
    s_waitcnt lgkmcnt(8)
    v_mfma_f32_16x16x32_bf16 v[128:131], v[152:155], v[176:179], v[128:131]
    ds_read_b128 v[172:175], v12 offset:6144
    v_mfma_f32_16x16x32_bf16 v[132:135], v[156:159], v[176:179], v[132:135]
    v_mfma_f32_16x16x32_bf16 v[136:139], v[160:163], v[176:179], v[136:139]
    s_waitcnt vmcnt(0)
    v_lshlrev_b32 v32, 16, v180
    v_and_b32 v33, 0xffff0000, v180
    v_lshlrev_b32 v34, 16, v181
    v_and_b32 v35, 0xffff0000, v181
    v_lshlrev_b32 v36, 16, v182
    v_and_b32 v37, 0xffff0000, v182
    v_lshlrev_b32 v38, 16, v183
    v_and_b32 v39, 0xffff0000, v183
    v_lshlrev_b32 v40, 16, v184
    v_and_b32 v41, 0xffff0000, v184
    v_lshlrev_b32 v42, 16, v185
    v_and_b32 v43, 0xffff0000, v185
    s_waitcnt lgkmcnt(1)
    v_mfma_f32_16x16x32_bf16 v[44:47], v[140:143], v[164:167], v[44:47]
    v_add_f32 v92, v92, v32
    v_add_f32 v93, v93, v33
    ds_read_b128 v[176:179], v12 offset:8192
    v_mfma_f32_16x16x32_bf16 v[48:51], v[144:147], v[164:167], v[48:51]
    v_add_f32 v96, v96, v36
    v_add_f32 v97, v97, v37
    v_mfma_f32_16x16x32_bf16 v[52:55], v[148:151], v[164:167], v[52:55]
    v_add_f32 v100, v100, v40
    v_add_f32 v101, v101, v41
    v_mfma_f32_16x16x32_bf16 v[56:59], v[140:143], v[168:171], v[56:59]
    v_add_f32 v104, v104, v32
    v_add_f32 v105, v105, v33
    ds_read_b128 v[164:167], v12 offset:10240
    v_mfma_f32_16x16x32_bf16 v[60:63], v[144:147], v[168:171], v[60:63]
    v_add_f32 v108, v108, v36
    v_add_f32 v109, v109, v37
    v_mfma_f32_16x16x32_bf16 v[64:67], v[148:151], v[168:171], v[64:67]
    v_add_f32 v112, v112, v40
    v_add_f32 v113, v113, v41
    s_waitcnt lgkmcnt(2)
    v_mfma_f32_16x16x32_bf16 v[68:71], v[140:143], v[172:175], v[68:71]
    v_add_f32 v116, v116, v32
    v_add_f32 v117, v117, v33
    ds_read_b128 v[168:171], v12 offset:12288
    v_mfma_f32_16x16x32_bf16 v[72:75], v[144:147], v[172:175], v[72:75]
    v_add_f32 v120, v120, v36
    v_add_f32 v121, v121, v37
    v_mfma_f32_16x16x32_bf16 v[76:79], v[148:151], v[172:175], v[76:79]
    v_add_f32 v124, v124, v40
    v_add_f32 v125, v125, v41
    s_waitcnt lgkmcnt(2)
    v_mfma_f32_16x16x32_bf16 v[80:83], v[140:143], v[176:179], v[80:83]
    v_add_f32 v128, v128, v32
    v_add_f32 v129, v129, v33
    ds_read_b128 v[172:175], v12 offset:14336
    v_mfma_f32_16x16x32_bf16 v[84:87], v[144:147], v[176:179], v[84:87]
    v_add_f32 v132, v132, v36
    v_add_f32 v133, v133, v37
    v_mfma_f32_16x16x32_bf16 v[88:91], v[148:151], v[176:179], v[88:91]
    v_add_f32 v136, v136, v40
    v_add_f32 v137, v137, v41
    s_barrier
    s_waitcnt lgkmcnt(2)
    v_mfma_f32_16x16x32_bf16 v[92:95], v[140:143], v[164:167], v[92:95]
    v_add_f32 v44, v44, v32
    v_add_f32 v45, v45, v33
    ds_read_b128 v[176:179], v12 offset:16384
    v_mfma_f32_16x16x32_bf16 v[96:99], v[144:147], v[164:167], v[96:99]
    v_add_f32 v48, v48, v36
    v_add_f32 v49, v49, v37
    ds_read_b64_tr_b16 v[152:153], v10 offset:36864
    ds_read_b64_tr_b16 v[154:155], v10 offset:37376
    v_mfma_f32_16x16x32_bf16 v[100:103], v[148:151], v[164:167], v[100:103]
    v_add_f32 v52, v52, v40
    v_add_f32 v53, v53, v41
    s_waitcnt lgkmcnt(4)
    v_mfma_f32_16x16x32_bf16 v[104:107], v[140:143], v[168:171], v[104:107]
    v_add_f32 v56, v56, v32
    v_add_f32 v57, v57, v33
    ds_read_b128 v[164:167], v13 offset:2048
    v_mfma_f32_16x16x32_bf16 v[108:111], v[144:147], v[168:171], v[108:111]
    v_add_f32 v60, v60, v36
    v_add_f32 v61, v61, v37
    ds_read_b64_tr_b16 v[156:157], v10 offset:40960
    ds_read_b64_tr_b16 v[158:159], v10 offset:41472
    v_mfma_f32_16x16x32_bf16 v[112:115], v[148:151], v[168:171], v[112:115]
    v_add_f32 v64, v64, v40
    v_add_f32 v65, v65, v41
    s_waitcnt lgkmcnt(6)
    v_mfma_f32_16x16x32_bf16 v[116:119], v[140:143], v[172:175], v[116:119]
    v_add_f32 v68, v68, v32
    v_add_f32 v69, v69, v33
    ds_read_b128 v[168:171], v13 offset:4096
    v_mfma_f32_16x16x32_bf16 v[120:123], v[144:147], v[172:175], v[120:123]
    v_add_f32 v72, v72, v36
    v_add_f32 v73, v73, v37
    ds_read_b64_tr_b16 v[160:161], v10 offset:45056
    ds_read_b64_tr_b16 v[162:163], v10 offset:45568
    v_mfma_f32_16x16x32_bf16 v[124:127], v[148:151], v[172:175], v[124:127]
    v_add_f32 v76, v76, v40
    v_add_f32 v77, v77, v41
    s_waitcnt lgkmcnt(8)
    v_mfma_f32_16x16x32_bf16 v[128:131], v[140:143], v[176:179], v[128:131]
    v_add_f32 v80, v80, v32
    v_add_f32 v81, v81, v33
    ds_read_b128 v[172:175], v13 offset:6144
    v_mfma_f32_16x16x32_bf16 v[132:135], v[144:147], v[176:179], v[132:135]
    v_add_f32 v84, v84, v36
    v_add_f32 v85, v85, v37
    v_mfma_f32_16x16x32_bf16 v[136:139], v[148:151], v[176:179], v[136:139]
    v_add_f32 v88, v88, v40
    v_add_f32 v89, v89, v41
    s_waitcnt lgkmcnt(1)
    v_mfma_f32_16x16x32_bf16 v[44:47], v[152:155], v[164:167], v[44:47]
    v_add_f32 v94, v94, v34
    v_add_f32 v95, v95, v35
    ds_read_b128 v[176:179], v13 offset:8192
    v_mfma_f32_16x16x32_bf16 v[48:51], v[156:159], v[164:167], v[48:51]
    v_add_f32 v98, v98, v38
    v_add_f32 v99, v99, v39
    v_mfma_f32_16x16x32_bf16 v[52:55], v[160:163], v[164:167], v[52:55]
    v_add_f32 v102, v102, v42
    v_add_f32 v103, v103, v43
    v_mfma_f32_16x16x32_bf16 v[56:59], v[152:155], v[168:171], v[56:59]
    v_add_f32 v106, v106, v34
    v_add_f32 v107, v107, v35
    ds_read_b128 v[164:167], v13 offset:10240
    v_mfma_f32_16x16x32_bf16 v[60:63], v[156:159], v[168:171], v[60:63]
    v_add_f32 v110, v110, v38
    v_add_f32 v111, v111, v39
    v_mfma_f32_16x16x32_bf16 v[64:67], v[160:163], v[168:171], v[64:67]
    v_add_f32 v114, v114, v42
    v_add_f32 v115, v115, v43
    s_waitcnt lgkmcnt(2)
    v_mfma_f32_16x16x32_bf16 v[68:71], v[152:155], v[172:175], v[68:71]
    v_add_f32 v118, v118, v34
    v_add_f32 v119, v119, v35
    ds_read_b128 v[168:171], v13 offset:12288
    v_mfma_f32_16x16x32_bf16 v[72:75], v[156:159], v[172:175], v[72:75]
    v_add_f32 v122, v122, v38
    v_add_f32 v123, v123, v39
    v_mfma_f32_16x16x32_bf16 v[76:79], v[160:163], v[172:175], v[76:79]
    v_add_f32 v126, v126, v42
    v_add_f32 v127, v127, v43
    s_waitcnt lgkmcnt(2)
    v_mfma_f32_16x16x32_bf16 v[80:83], v[152:155], v[176:179], v[80:83]
    v_add_f32 v130, v130, v34
    v_add_f32 v131, v131, v35
    ds_read_b128 v[172:175], v13 offset:14336
    v_mfma_f32_16x16x32_bf16 v[84:87], v[156:159], v[176:179], v[84:87]
    v_add_f32 v134, v134, v38
    v_add_f32 v135, v135, v39
    v_mfma_f32_16x16x32_bf16 v[88:91], v[160:163], v[176:179], v[88:91]
    v_add_f32 v138, v138, v42
    v_add_f32 v139, v139, v43
    s_barrier
    s_waitcnt lgkmcnt(2)
    v_mfma_f32_16x16x32_bf16 v[92:95], v[152:155], v[164:167], v[92:95]
    v_add_f32 v46, v46, v34
    v_add_f32 v47, v47, v35
    ds_read_b128 v[176:179], v13 offset:16384
    v_mfma_f32_16x16x32_bf16 v[96:99], v[156:159], v[164:167], v[96:99]
    v_add_f32 v50, v50, v38
    v_add_f32 v51, v51, v39
    ds_read_b64_tr_b16 v[140:141], v10 offset:49152
    ds_read_b64_tr_b16 v[142:143], v10 offset:49664
    v_mfma_f32_16x16x32_bf16 v[100:103], v[160:163], v[164:167], v[100:103]
    v_add_f32 v54, v54, v42
    v_add_f32 v55, v55, v43
    s_waitcnt lgkmcnt(4)
    v_mfma_f32_16x16x32_bf16 v[104:107], v[152:155], v[168:171], v[104:107]
    v_add_f32 v58, v58, v34
    v_add_f32 v59, v59, v35
    ds_read_b128 v[164:167], v12 offset:20480
    v_mfma_f32_16x16x32_bf16 v[108:111], v[156:159], v[168:171], v[108:111]
    v_add_f32 v62, v62, v38
    v_add_f32 v63, v63, v39
    ds_read_b64_tr_b16 v[144:145], v10 offset:53248
    ds_read_b64_tr_b16 v[146:147], v10 offset:53760
    v_mfma_f32_16x16x32_bf16 v[112:115], v[160:163], v[168:171], v[112:115]
    v_add_f32 v66, v66, v42
    v_add_f32 v67, v67, v43
    s_waitcnt lgkmcnt(6)
    v_mfma_f32_16x16x32_bf16 v[116:119], v[152:155], v[172:175], v[116:119]
    v_add_f32 v70, v70, v34
    v_add_f32 v71, v71, v35
    ds_read_b128 v[168:171], v12 offset:22528
    v_mfma_f32_16x16x32_bf16 v[120:123], v[156:159], v[172:175], v[120:123]
    v_add_f32 v74, v74, v38
    v_add_f32 v75, v75, v39
    ds_read_b64_tr_b16 v[148:149], v10 offset:57344
    ds_read_b64_tr_b16 v[150:151], v10 offset:57856
    v_mfma_f32_16x16x32_bf16 v[124:127], v[160:163], v[172:175], v[124:127]
    v_add_f32 v78, v78, v42
    v_add_f32 v79, v79, v43
    s_waitcnt lgkmcnt(8)
    v_mfma_f32_16x16x32_bf16 v[128:131], v[152:155], v[176:179], v[128:131]
    v_add_f32 v82, v82, v34
    v_add_f32 v83, v83, v35
    ds_read_b128 v[172:175], v12 offset:24576
    v_mfma_f32_16x16x32_bf16 v[132:135], v[156:159], v[176:179], v[132:135]
    v_add_f32 v86, v86, v38
    v_add_f32 v87, v87, v39
    v_mfma_f32_16x16x32_bf16 v[136:139], v[160:163], v[176:179], v[136:139]
    v_add_f32 v90, v90, v42
    v_add_f32 v91, v91, v43
    s_waitcnt lgkmcnt(1)
    v_mfma_f32_16x16x32_bf16 v[44:47], v[140:143], v[164:167], v[44:47]
    ds_read_b128 v[176:179], v12 offset:26624
    v_mfma_f32_16x16x32_bf16 v[48:51], v[144:147], v[164:167], v[48:51]
    v_mfma_f32_16x16x32_bf16 v[52:55], v[148:151], v[164:167], v[52:55]
    v_mfma_f32_16x16x32_bf16 v[56:59], v[140:143], v[168:171], v[56:59]
    ds_read_b128 v[164:167], v12 offset:28672
    v_mfma_f32_16x16x32_bf16 v[60:63], v[144:147], v[168:171], v[60:63]
    v_mfma_f32_16x16x32_bf16 v[64:67], v[148:151], v[168:171], v[64:67]
    s_waitcnt lgkmcnt(2)
    v_mfma_f32_16x16x32_bf16 v[68:71], v[140:143], v[172:175], v[68:71]
    ds_read_b128 v[168:171], v12 offset:30720
    v_mfma_f32_16x16x32_bf16 v[72:75], v[144:147], v[172:175], v[72:75]
    v_mfma_f32_16x16x32_bf16 v[76:79], v[148:151], v[172:175], v[76:79]
    s_waitcnt lgkmcnt(2)
    v_mfma_f32_16x16x32_bf16 v[80:83], v[140:143], v[176:179], v[80:83]
    ds_read_b128 v[172:175], v12 offset:32768
    v_mfma_f32_16x16x32_bf16 v[84:87], v[144:147], v[176:179], v[84:87]
    v_mfma_f32_16x16x32_bf16 v[88:91], v[148:151], v[176:179], v[88:91]
    s_barrier
    s_waitcnt lgkmcnt(2)
    v_mfma_f32_16x16x32_bf16 v[92:95], v[140:143], v[164:167], v[92:95]
    ds_read_b128 v[176:179], v12 offset:34816
    v_mfma_f32_16x16x32_bf16 v[96:99], v[144:147], v[164:167], v[96:99]
    ds_read_b64_tr_b16 v[152:153], v11 offset:0
    ds_read_b64_tr_b16 v[154:155], v11 offset:512
    v_mfma_f32_16x16x32_bf16 v[100:103], v[148:151], v[164:167], v[100:103]
    s_waitcnt lgkmcnt(4)
    v_mfma_f32_16x16x32_bf16 v[104:107], v[140:143], v[168:171], v[104:107]
    ds_read_b128 v[164:167], v13 offset:20480
    v_mfma_f32_16x16x32_bf16 v[108:111], v[144:147], v[168:171], v[108:111]
    ds_read_b64_tr_b16 v[156:157], v11 offset:4096
    ds_read_b64_tr_b16 v[158:159], v11 offset:4608
    v_mfma_f32_16x16x32_bf16 v[112:115], v[148:151], v[168:171], v[112:115]
    s_waitcnt lgkmcnt(6)
    v_mfma_f32_16x16x32_bf16 v[116:119], v[140:143], v[172:175], v[116:119]
    ds_read_b128 v[168:171], v13 offset:22528
    v_mfma_f32_16x16x32_bf16 v[120:123], v[144:147], v[172:175], v[120:123]
    ds_read_b64_tr_b16 v[160:161], v11 offset:8192
    ds_read_b64_tr_b16 v[162:163], v11 offset:8704
    v_mfma_f32_16x16x32_bf16 v[124:127], v[148:151], v[172:175], v[124:127]
    s_waitcnt lgkmcnt(8)
    v_mfma_f32_16x16x32_bf16 v[128:131], v[140:143], v[176:179], v[128:131]
    ds_read_b128 v[172:175], v13 offset:24576
    v_mfma_f32_16x16x32_bf16 v[132:135], v[144:147], v[176:179], v[132:135]
    v_mfma_f32_16x16x32_bf16 v[136:139], v[148:151], v[176:179], v[136:139]
    s_waitcnt lgkmcnt(1)
    v_mfma_f32_16x16x32_bf16 v[44:47], v[152:155], v[164:167], v[44:47]
    ds_read_b128 v[176:179], v13 offset:26624
    v_mfma_f32_16x16x32_bf16 v[48:51], v[156:159], v[164:167], v[48:51]
    v_mfma_f32_16x16x32_bf16 v[52:55], v[160:163], v[164:167], v[52:55]
    v_mfma_f32_16x16x32_bf16 v[56:59], v[152:155], v[168:171], v[56:59]
    ds_read_b128 v[164:167], v13 offset:28672
    v_mfma_f32_16x16x32_bf16 v[60:63], v[156:159], v[168:171], v[60:63]
    v_mfma_f32_16x16x32_bf16 v[64:67], v[160:163], v[168:171], v[64:67]
    s_waitcnt lgkmcnt(2)
    v_mfma_f32_16x16x32_bf16 v[68:71], v[152:155], v[172:175], v[68:71]
    ds_read_b128 v[168:171], v13 offset:30720
    v_mfma_f32_16x16x32_bf16 v[72:75], v[156:159], v[172:175], v[72:75]
    v_mfma_f32_16x16x32_bf16 v[76:79], v[160:163], v[172:175], v[76:79]
    s_waitcnt lgkmcnt(2)
    v_mfma_f32_16x16x32_bf16 v[80:83], v[152:155], v[176:179], v[80:83]
    ds_read_b128 v[172:175], v13 offset:32768
    v_mfma_f32_16x16x32_bf16 v[84:87], v[156:159], v[176:179], v[84:87]
    v_mfma_f32_16x16x32_bf16 v[88:91], v[160:163], v[176:179], v[88:91]
    s_barrier
    s_waitcnt lgkmcnt(2)
    v_mfma_f32_16x16x32_bf16 v[92:95], v[152:155], v[164:167], v[92:95]
    ds_read_b128 v[176:179], v13 offset:34816
    v_mfma_f32_16x16x32_bf16 v[96:99], v[156:159], v[164:167], v[96:99]
    ds_read_b64_tr_b16 v[140:141], v10 offset:0
    ds_read_b64_tr_b16 v[142:143], v10 offset:512
    v_mfma_f32_16x16x32_bf16 v[100:103], v[160:163], v[164:167], v[100:103]
    s_waitcnt lgkmcnt(4)
    v_mfma_f32_16x16x32_bf16 v[104:107], v[152:155], v[168:171], v[104:107]
    ds_read_b128 v[164:167], v14 offset:2048
    v_mfma_f32_16x16x32_bf16 v[108:111], v[156:159], v[168:171], v[108:111]
    ds_read_b64_tr_b16 v[144:145], v10 offset:4096
    ds_read_b64_tr_b16 v[146:147], v10 offset:4608
    v_mfma_f32_16x16x32_bf16 v[112:115], v[160:163], v[168:171], v[112:115]
    s_waitcnt lgkmcnt(6)
    v_mfma_f32_16x16x32_bf16 v[116:119], v[152:155], v[172:175], v[116:119]
    ds_read_b128 v[168:171], v14 offset:4096
    v_mfma_f32_16x16x32_bf16 v[120:123], v[156:159], v[172:175], v[120:123]
    ds_read_b64_tr_b16 v[148:149], v10 offset:8192
    ds_read_b64_tr_b16 v[150:151], v10 offset:8704
    v_mfma_f32_16x16x32_bf16 v[124:127], v[160:163], v[172:175], v[124:127]
    s_waitcnt lgkmcnt(8)
    v_mfma_f32_16x16x32_bf16 v[128:131], v[152:155], v[176:179], v[128:131]
    ds_read_b128 v[172:175], v14 offset:6144
    v_mfma_f32_16x16x32_bf16 v[132:135], v[156:159], v[176:179], v[132:135]
    v_mfma_f32_16x16x32_bf16 v[136:139], v[160:163], v[176:179], v[136:139]
    s_waitcnt lgkmcnt(1)
    v_mfma_f32_16x16x32_bf16 v[44:47], v[140:143], v[164:167], v[44:47]
    ds_read_b128 v[176:179], v14 offset:8192
    v_mfma_f32_16x16x32_bf16 v[48:51], v[144:147], v[164:167], v[48:51]
    v_mfma_f32_16x16x32_bf16 v[52:55], v[148:151], v[164:167], v[52:55]
    v_mfma_f32_16x16x32_bf16 v[56:59], v[140:143], v[168:171], v[56:59]
    ds_read_b128 v[164:167], v14 offset:10240
    v_mfma_f32_16x16x32_bf16 v[60:63], v[144:147], v[168:171], v[60:63]
    v_mfma_f32_16x16x32_bf16 v[64:67], v[148:151], v[168:171], v[64:67]
    s_waitcnt lgkmcnt(2)
    v_mfma_f32_16x16x32_bf16 v[68:71], v[140:143], v[172:175], v[68:71]
    ds_read_b128 v[168:171], v14 offset:12288
    v_mfma_f32_16x16x32_bf16 v[72:75], v[144:147], v[172:175], v[72:75]
    v_mfma_f32_16x16x32_bf16 v[76:79], v[148:151], v[172:175], v[76:79]
    s_waitcnt lgkmcnt(2)
    v_mfma_f32_16x16x32_bf16 v[80:83], v[140:143], v[176:179], v[80:83]
    ds_read_b128 v[172:175], v14 offset:14336
    v_mfma_f32_16x16x32_bf16 v[84:87], v[144:147], v[176:179], v[84:87]
    v_mfma_f32_16x16x32_bf16 v[88:91], v[148:151], v[176:179], v[88:91]
    s_barrier
    s_waitcnt lgkmcnt(2)
    v_mfma_f32_16x16x32_bf16 v[92:95], v[140:143], v[164:167], v[92:95]
    ds_read_b128 v[176:179], v14 offset:16384
    v_mfma_f32_16x16x32_bf16 v[96:99], v[144:147], v[164:167], v[96:99]
    ds_read_b64_tr_b16 v[152:153], v10 offset:12288
    ds_read_b64_tr_b16 v[154:155], v10 offset:12800
    v_mfma_f32_16x16x32_bf16 v[100:103], v[148:151], v[164:167], v[100:103]
    s_waitcnt lgkmcnt(4)
    v_mfma_f32_16x16x32_bf16 v[104:107], v[140:143], v[168:171], v[104:107]
    ds_read_b128 v[164:167], v15 offset:2048
    v_mfma_f32_16x16x32_bf16 v[108:111], v[144:147], v[168:171], v[108:111]
    ds_read_b64_tr_b16 v[156:157], v10 offset:16384
    ds_read_b64_tr_b16 v[158:159], v10 offset:16896
    v_mfma_f32_16x16x32_bf16 v[112:115], v[148:151], v[168:171], v[112:115]
    s_waitcnt lgkmcnt(6)
    v_mfma_f32_16x16x32_bf16 v[116:119], v[140:143], v[172:175], v[116:119]
    ds_read_b128 v[168:171], v15 offset:4096
    v_mfma_f32_16x16x32_bf16 v[120:123], v[144:147], v[172:175], v[120:123]
    ds_read_b64_tr_b16 v[160:161], v10 offset:20480
    ds_read_b64_tr_b16 v[162:163], v10 offset:20992
    v_mfma_f32_16x16x32_bf16 v[124:127], v[148:151], v[172:175], v[124:127]
    s_waitcnt lgkmcnt(8)
    v_mfma_f32_16x16x32_bf16 v[128:131], v[140:143], v[176:179], v[128:131]
    ds_read_b128 v[172:175], v15 offset:6144
    v_mfma_f32_16x16x32_bf16 v[132:135], v[144:147], v[176:179], v[132:135]
    v_mfma_f32_16x16x32_bf16 v[136:139], v[148:151], v[176:179], v[136:139]
    s_waitcnt lgkmcnt(1)
    v_mfma_f32_16x16x32_bf16 v[44:47], v[152:155], v[164:167], v[44:47]
    ds_read_b128 v[176:179], v15 offset:8192
    v_mfma_f32_16x16x32_bf16 v[48:51], v[156:159], v[164:167], v[48:51]
    v_mfma_f32_16x16x32_bf16 v[52:55], v[160:163], v[164:167], v[52:55]
    v_mfma_f32_16x16x32_bf16 v[56:59], v[152:155], v[168:171], v[56:59]
    ds_read_b128 v[164:167], v15 offset:10240
    v_mfma_f32_16x16x32_bf16 v[60:63], v[156:159], v[168:171], v[60:63]
    v_mfma_f32_16x16x32_bf16 v[64:67], v[160:163], v[168:171], v[64:67]
    s_waitcnt lgkmcnt(2)
    v_mfma_f32_16x16x32_bf16 v[68:71], v[152:155], v[172:175], v[68:71]
    ds_read_b128 v[168:171], v15 offset:12288
    v_mfma_f32_16x16x32_bf16 v[72:75], v[156:159], v[172:175], v[72:75]
    v_mfma_f32_16x16x32_bf16 v[76:79], v[160:163], v[172:175], v[76:79]
    s_waitcnt lgkmcnt(2)
    v_mfma_f32_16x16x32_bf16 v[80:83], v[152:155], v[176:179], v[80:83]
    ds_read_b128 v[172:175], v15 offset:14336
    v_mfma_f32_16x16x32_bf16 v[84:87], v[156:159], v[176:179], v[84:87]
    v_mfma_f32_16x16x32_bf16 v[88:91], v[160:163], v[176:179], v[88:91]
    s_barrier
    s_waitcnt lgkmcnt(2)
    v_mfma_f32_16x16x32_bf16 v[92:95], v[152:155], v[164:167], v[92:95]
    ds_read_b128 v[176:179], v15 offset:16384
    v_mfma_f32_16x16x32_bf16 v[96:99], v[156:159], v[164:167], v[96:99]
    ds_read_b64_tr_b16 v[140:141], v10 offset:24576
    ds_read_b64_tr_b16 v[142:143], v10 offset:25088
    v_mfma_f32_16x16x32_bf16 v[100:103], v[160:163], v[164:167], v[100:103]
    s_waitcnt lgkmcnt(4)
    v_mfma_f32_16x16x32_bf16 v[104:107], v[152:155], v[168:171], v[104:107]
    ds_read_b128 v[164:167], v14 offset:20480
    v_mfma_f32_16x16x32_bf16 v[108:111], v[156:159], v[168:171], v[108:111]
    ds_read_b64_tr_b16 v[144:145], v10 offset:28672
    ds_read_b64_tr_b16 v[146:147], v10 offset:29184
    v_mfma_f32_16x16x32_bf16 v[112:115], v[160:163], v[168:171], v[112:115]
    s_waitcnt lgkmcnt(6)
    v_mfma_f32_16x16x32_bf16 v[116:119], v[152:155], v[172:175], v[116:119]
    ds_read_b128 v[168:171], v14 offset:22528
    v_mfma_f32_16x16x32_bf16 v[120:123], v[156:159], v[172:175], v[120:123]
    ds_read_b64_tr_b16 v[148:149], v10 offset:32768
    ds_read_b64_tr_b16 v[150:151], v10 offset:33280
    v_mfma_f32_16x16x32_bf16 v[124:127], v[160:163], v[172:175], v[124:127]
    s_waitcnt lgkmcnt(8)
    v_mfma_f32_16x16x32_bf16 v[128:131], v[152:155], v[176:179], v[128:131]
    ds_read_b128 v[172:175], v14 offset:24576
    v_mfma_f32_16x16x32_bf16 v[132:135], v[156:159], v[176:179], v[132:135]
    v_mfma_f32_16x16x32_bf16 v[136:139], v[160:163], v[176:179], v[136:139]
    s_waitcnt lgkmcnt(1)
    v_mfma_f32_16x16x32_bf16 v[44:47], v[140:143], v[164:167], v[44:47]
    ds_read_b128 v[176:179], v14 offset:26624
    v_mfma_f32_16x16x32_bf16 v[48:51], v[144:147], v[164:167], v[48:51]
    v_mfma_f32_16x16x32_bf16 v[52:55], v[148:151], v[164:167], v[52:55]
    v_mfma_f32_16x16x32_bf16 v[56:59], v[140:143], v[168:171], v[56:59]
    ds_read_b128 v[164:167], v14 offset:28672
    v_mfma_f32_16x16x32_bf16 v[60:63], v[144:147], v[168:171], v[60:63]
    v_mfma_f32_16x16x32_bf16 v[64:67], v[148:151], v[168:171], v[64:67]
    s_waitcnt lgkmcnt(2)
    v_mfma_f32_16x16x32_bf16 v[68:71], v[140:143], v[172:175], v[68:71]
    ds_read_b128 v[168:171], v14 offset:30720
    v_mfma_f32_16x16x32_bf16 v[72:75], v[144:147], v[172:175], v[72:75]
    v_mfma_f32_16x16x32_bf16 v[76:79], v[148:151], v[172:175], v[76:79]
    s_waitcnt lgkmcnt(2)
    v_mfma_f32_16x16x32_bf16 v[80:83], v[140:143], v[176:179], v[80:83]
    ds_read_b128 v[172:175], v14 offset:32768
    v_mfma_f32_16x16x32_bf16 v[84:87], v[144:147], v[176:179], v[84:87]
    v_mfma_f32_16x16x32_bf16 v[88:91], v[148:151], v[176:179], v[88:91]
    s_barrier
    s_waitcnt lgkmcnt(2)
    v_mfma_f32_16x16x32_bf16 v[92:95], v[140:143], v[164:167], v[92:95]
    ds_read_b128 v[176:179], v14 offset:34816
    v_mfma_f32_16x16x32_bf16 v[96:99], v[144:147], v[164:167], v[96:99]
    ds_read_b64_tr_b16 v[152:153], v10 offset:36864
    ds_read_b64_tr_b16 v[154:155], v10 offset:37376
    v_mfma_f32_16x16x32_bf16 v[100:103], v[148:151], v[164:167], v[100:103]
    s_waitcnt lgkmcnt(4)
    v_mfma_f32_16x16x32_bf16 v[104:107], v[140:143], v[168:171], v[104:107]
    ds_read_b128 v[164:167], v15 offset:20480
    v_mfma_f32_16x16x32_bf16 v[108:111], v[144:147], v[168:171], v[108:111]
    ds_read_b64_tr_b16 v[156:157], v10 offset:40960
    ds_read_b64_tr_b16 v[158:159], v10 offset:41472
    v_mfma_f32_16x16x32_bf16 v[112:115], v[148:151], v[168:171], v[112:115]
    s_waitcnt lgkmcnt(6)
    v_mfma_f32_16x16x32_bf16 v[116:119], v[140:143], v[172:175], v[116:119]
    ds_read_b128 v[168:171], v15 offset:22528
    v_mfma_f32_16x16x32_bf16 v[120:123], v[144:147], v[172:175], v[120:123]
    ds_read_b64_tr_b16 v[160:161], v10 offset:45056
    ds_read_b64_tr_b16 v[162:163], v10 offset:45568
    v_mfma_f32_16x16x32_bf16 v[124:127], v[148:151], v[172:175], v[124:127]
    s_waitcnt lgkmcnt(8)
    v_mfma_f32_16x16x32_bf16 v[128:131], v[140:143], v[176:179], v[128:131]
    ds_read_b128 v[172:175], v15 offset:24576
    v_mfma_f32_16x16x32_bf16 v[132:135], v[144:147], v[176:179], v[132:135]
    v_mfma_f32_16x16x32_bf16 v[136:139], v[148:151], v[176:179], v[136:139]
    s_waitcnt lgkmcnt(1)
    v_mfma_f32_16x16x32_bf16 v[44:47], v[152:155], v[164:167], v[44:47]
    ds_read_b128 v[176:179], v15 offset:26624
    v_mfma_f32_16x16x32_bf16 v[48:51], v[156:159], v[164:167], v[48:51]
    v_mfma_f32_16x16x32_bf16 v[52:55], v[160:163], v[164:167], v[52:55]
    v_mfma_f32_16x16x32_bf16 v[56:59], v[152:155], v[168:171], v[56:59]
    ds_read_b128 v[164:167], v15 offset:28672
    v_mfma_f32_16x16x32_bf16 v[60:63], v[156:159], v[168:171], v[60:63]
    v_mfma_f32_16x16x32_bf16 v[64:67], v[160:163], v[168:171], v[64:67]
    s_waitcnt lgkmcnt(2)
    v_mfma_f32_16x16x32_bf16 v[68:71], v[152:155], v[172:175], v[68:71]
    ds_read_b128 v[168:171], v15 offset:30720
    v_mfma_f32_16x16x32_bf16 v[72:75], v[156:159], v[172:175], v[72:75]
    v_mfma_f32_16x16x32_bf16 v[76:79], v[160:163], v[172:175], v[76:79]
    s_waitcnt lgkmcnt(2)
    v_mfma_f32_16x16x32_bf16 v[80:83], v[152:155], v[176:179], v[80:83]
    ds_read_b128 v[172:175], v15 offset:32768
    v_mfma_f32_16x16x32_bf16 v[84:87], v[156:159], v[176:179], v[84:87]
    v_mfma_f32_16x16x32_bf16 v[88:91], v[160:163], v[176:179], v[88:91]
    s_waitcnt lgkmcnt(2)
    v_mfma_f32_16x16x32_bf16 v[92:95], v[152:155], v[164:167], v[92:95]
    ds_read_b128 v[176:179], v15 offset:34816
    v_mfma_f32_16x16x32_bf16 v[96:99], v[156:159], v[164:167], v[96:99]
    v_mfma_f32_16x16x32_bf16 v[100:103], v[160:163], v[164:167], v[100:103]
    s_waitcnt lgkmcnt(2)
    v_mfma_f32_16x16x32_bf16 v[104:107], v[152:155], v[168:171], v[104:107]
    v_mfma_f32_16x16x32_bf16 v[108:111], v[156:159], v[168:171], v[108:111]
    v_mfma_f32_16x16x32_bf16 v[112:115], v[160:163], v[168:171], v[112:115]
    s_waitcnt lgkmcnt(1)
    v_mfma_f32_16x16x32_bf16 v[116:119], v[152:155], v[172:175], v[116:119]
    v_mfma_f32_16x16x32_bf16 v[120:123], v[156:159], v[172:175], v[120:123]
    v_mfma_f32_16x16x32_bf16 v[124:127], v[160:163], v[172:175], v[124:127]
    s_waitcnt lgkmcnt(0)
    v_mfma_f32_16x16x32_bf16 v[128:131], v[152:155], v[176:179], v[128:131]
    v_mfma_f32_16x16x32_bf16 v[132:135], v[156:159], v[176:179], v[132:135]
    v_mfma_f32_16x16x32_bf16 v[136:139], v[160:163], v[176:179], v[136:139]
    s_barrier
    v_mov_b32 v4, 0
    global_load_dword v9, v4, s[28:29] sc1
    s_cmp_ge_u32 s44, 86
    s_cbranch_scc1 L_fused_ffnskip25
    v_pk_mul_f32 v[140:141], v[44:45], s[42:43] op_sel_hi:[1,0]
    v_pk_mul_f32 v[142:143], v[46:47], s[42:43] op_sel_hi:[1,0]
    v_pk_mul_f32 v[144:145], v[56:57], s[42:43] op_sel_hi:[1,0]
    v_pk_mul_f32 v[146:147], v[58:59], s[42:43] op_sel_hi:[1,0]
    v_exp_f32 v140, v140
    v_exp_f32 v141, v141
    v_exp_f32 v142, v142
    v_exp_f32 v143, v143
    v_exp_f32 v144, v144
    v_exp_f32 v145, v145
    v_exp_f32 v146, v146
    v_exp_f32 v147, v147
    v_pk_add_f32 v[148:149], v[140:141], 2.0 op_sel_hi:[1,0]
    v_pk_add_f32 v[150:151], v[142:143], 2.0 op_sel_hi:[1,0]
    v_pk_add_f32 v[152:153], v[144:145], 2.0 op_sel_hi:[1,0]
    v_pk_add_f32 v[154:155], v[146:147], 2.0 op_sel_hi:[1,0]
    v_pk_fma_f32 v[148:149], v[140:141], v[148:149], 2.0 op_sel_hi:[1,1,0]
    v_pk_fma_f32 v[150:151], v[142:143], v[150:151], 2.0 op_sel_hi:[1,1,0]
    v_pk_fma_f32 v[152:153], v[144:145], v[152:153], 2.0 op_sel_hi:[1,1,0]
    v_pk_fma_f32 v[154:155], v[146:147], v[154:155], 2.0 op_sel_hi:[1,1,0]
    v_rcp_f32 v148, v148
    v_rcp_f32 v149, v149
    v_rcp_f32 v150, v150
    v_rcp_f32 v151, v151
    v_rcp_f32 v152, v152
    v_rcp_f32 v153, v153
    v_rcp_f32 v154, v154
    v_rcp_f32 v155, v155
    v_pk_fma_f32 v[148:149], v[148:149], -2.0, 1.0 op_sel_hi:[1,0,0]
    v_pk_fma_f32 v[150:151], v[150:151], -2.0, 1.0 op_sel_hi:[1,0,0]
    v_pk_fma_f32 v[152:153], v[152:153], -2.0, 1.0 op_sel_hi:[1,0,0]
    v_pk_fma_f32 v[154:155], v[154:155], -2.0, 1.0 op_sel_hi:[1,0,0]
    v_pk_mul_f32 v[148:149], v[44:45], v[148:149]
    v_pk_mul_f32 v[150:151], v[46:47], v[150:151]
    v_pk_mul_f32 v[152:153], v[56:57], v[152:153]
    v_pk_mul_f32 v[154:155], v[58:59], v[154:155]
    v_cvt_pk_bf16_f32 v156, v148, v149
    v_cvt_pk_bf16_f32 v157, v150, v151
    v_cvt_pk_bf16_f32 v158, v152, v153
    v_cvt_pk_bf16_f32 v159, v154, v155
    s_nop 0
    v_permlane16_swap_b32 v156, v158
    v_permlane16_swap_b32 v157, v159
    s_add_u32 s46, s51, 0
    buffer_store_dwordx4 v[156:159], v16, s[16:19], s46 offen sc1
    v_pk_mul_f32 v[164:165], v[68:69], s[42:43] op_sel_hi:[1,0]
    v_pk_mul_f32 v[166:167], v[70:71], s[42:43] op_sel_hi:[1,0]
    v_pk_mul_f32 v[168:169], v[80:81], s[42:43] op_sel_hi:[1,0]
    v_pk_mul_f32 v[170:171], v[82:83], s[42:43] op_sel_hi:[1,0]
    v_exp_f32 v164, v164
    v_exp_f32 v165, v165
    v_exp_f32 v166, v166
    v_exp_f32 v167, v167
    v_exp_f32 v168, v168
    v_exp_f32 v169, v169
    v_exp_f32 v170, v170
    v_exp_f32 v171, v171
    v_pk_add_f32 v[172:173], v[164:165], 2.0 op_sel_hi:[1,0]
    v_pk_add_f32 v[174:175], v[166:167], 2.0 op_sel_hi:[1,0]
    v_pk_add_f32 v[176:177], v[168:169], 2.0 op_sel_hi:[1,0]
    v_pk_add_f32 v[178:179], v[170:171], 2.0 op_sel_hi:[1,0]
    v_pk_fma_f32 v[172:173], v[164:165], v[172:173], 2.0 op_sel_hi:[1,1,0]
    v_pk_fma_f32 v[174:175], v[166:167], v[174:175], 2.0 op_sel_hi:[1,1,0]
    v_pk_fma_f32 v[176:177], v[168:169], v[176:177], 2.0 op_sel_hi:[1,1,0]
    v_pk_fma_f32 v[178:179], v[170:171], v[178:179], 2.0 op_sel_hi:[1,1,0]
    v_rcp_f32 v172, v172
    v_rcp_f32 v173, v173
    v_rcp_f32 v174, v174
    v_rcp_f32 v175, v175
    v_rcp_f32 v176, v176
    v_rcp_f32 v177, v177
    v_rcp_f32 v178, v178
    v_rcp_f32 v179, v179
    v_pk_fma_f32 v[172:173], v[172:173], -2.0, 1.0 op_sel_hi:[1,0,0]
    v_pk_fma_f32 v[174:175], v[174:175], -2.0, 1.0 op_sel_hi:[1,0,0]
    v_pk_fma_f32 v[176:177], v[176:177], -2.0, 1.0 op_sel_hi:[1,0,0]
    v_pk_fma_f32 v[178:179], v[178:179], -2.0, 1.0 op_sel_hi:[1,0,0]
    v_pk_mul_f32 v[172:173], v[68:69], v[172:173]
    v_pk_mul_f32 v[174:175], v[70:71], v[174:175]
    v_pk_mul_f32 v[176:177], v[80:81], v[176:177]
    v_pk_mul_f32 v[178:179], v[82:83], v[178:179]
    v_cvt_pk_bf16_f32 v180, v172, v173
    v_cvt_pk_bf16_f32 v181, v174, v175
    v_cvt_pk_bf16_f32 v182, v176, v177
    v_cvt_pk_bf16_f32 v183, v178, v179
    s_nop 0
    v_permlane16_swap_b32 v180, v182
    v_permlane16_swap_b32 v181, v183
    s_add_u32 s46, s51, 120832
    buffer_store_dwordx4 v[180:183], v16, s[16:19], s46 offen sc1
    v_pk_mul_f32 v[140:141], v[92:93], s[42:43] op_sel_hi:[1,0]
    v_pk_mul_f32 v[142:143], v[94:95], s[42:43] op_sel_hi:[1,0]
    v_pk_mul_f32 v[144:145], v[104:105], s[42:43] op_sel_hi:[1,0]
    v_pk_mul_f32 v[146:147], v[106:107], s[42:43] op_sel_hi:[1,0]
    v_exp_f32 v140, v140
    v_exp_f32 v141, v141
    v_exp_f32 v142, v142
    v_exp_f32 v143, v143
    v_exp_f32 v144, v144
    v_exp_f32 v145, v145
    v_exp_f32 v146, v146
    v_exp_f32 v147, v147
    v_pk_add_f32 v[148:149], v[140:141], 2.0 op_sel_hi:[1,0]
    v_pk_add_f32 v[150:151], v[142:143], 2.0 op_sel_hi:[1,0]
    v_pk_add_f32 v[152:153], v[144:145], 2.0 op_sel_hi:[1,0]
    v_pk_add_f32 v[154:155], v[146:147], 2.0 op_sel_hi:[1,0]
    v_pk_fma_f32 v[148:149], v[140:141], v[148:149], 2.0 op_sel_hi:[1,1,0]
    v_pk_fma_f32 v[150:151], v[142:143], v[150:151], 2.0 op_sel_hi:[1,1,0]
    v_pk_fma_f32 v[152:153], v[144:145], v[152:153], 2.0 op_sel_hi:[1,1,0]
    v_pk_fma_f32 v[154:155], v[146:147], v[154:155], 2.0 op_sel_hi:[1,1,0]
    v_rcp_f32 v148, v148
    v_rcp_f32 v149, v149
    v_rcp_f32 v150, v150
    v_rcp_f32 v151, v151
    v_rcp_f32 v152, v152
    v_rcp_f32 v153, v153
    v_rcp_f32 v154, v154
    v_rcp_f32 v155, v155
    v_pk_fma_f32 v[148:149], v[148:149], -2.0, 1.0 op_sel_hi:[1,0,0]
    v_pk_fma_f32 v[150:151], v[150:151], -2.0, 1.0 op_sel_hi:[1,0,0]
    v_pk_fma_f32 v[152:153], v[152:153], -2.0, 1.0 op_sel_hi:[1,0,0]
    v_pk_fma_f32 v[154:155], v[154:155], -2.0, 1.0 op_sel_hi:[1,0,0]
    v_pk_mul_f32 v[148:149], v[92:93], v[148:149]
    v_pk_mul_f32 v[150:151], v[94:95], v[150:151]
    v_pk_mul_f32 v[152:153], v[104:105], v[152:153]
    v_pk_mul_f32 v[154:155], v[106:107], v[154:155]
    v_cvt_pk_bf16_f32 v156, v148, v149
    v_cvt_pk_bf16_f32 v157, v150, v151
    v_cvt_pk_bf16_f32 v158, v152, v153
    v_cvt_pk_bf16_f32 v159, v154, v155
    s_nop 0
    v_permlane16_swap_b32 v156, v158
    v_permlane16_swap_b32 v157, v159
    s_add_u32 s46, s51, 241664
    buffer_store_dwordx4 v[156:159], v16, s[16:19], s46 offen sc1
    v_pk_mul_f32 v[164:165], v[116:117], s[42:43] op_sel_hi:[1,0]
    v_pk_mul_f32 v[166:167], v[118:119], s[42:43] op_sel_hi:[1,0]
    v_pk_mul_f32 v[168:169], v[128:129], s[42:43] op_sel_hi:[1,0]
    v_pk_mul_f32 v[170:171], v[130:131], s[42:43] op_sel_hi:[1,0]
    v_exp_f32 v164, v164
    v_exp_f32 v165, v165
    v_exp_f32 v166, v166
    v_exp_f32 v167, v167
    v_exp_f32 v168, v168
    v_exp_f32 v169, v169
    v_exp_f32 v170, v170
    v_exp_f32 v171, v171
    v_pk_add_f32 v[172:173], v[164:165], 2.0 op_sel_hi:[1,0]
    v_pk_add_f32 v[174:175], v[166:167], 2.0 op_sel_hi:[1,0]
    v_pk_add_f32 v[176:177], v[168:169], 2.0 op_sel_hi:[1,0]
    v_pk_add_f32 v[178:179], v[170:171], 2.0 op_sel_hi:[1,0]
    v_pk_fma_f32 v[172:173], v[164:165], v[172:173], 2.0 op_sel_hi:[1,1,0]
    v_pk_fma_f32 v[174:175], v[166:167], v[174:175], 2.0 op_sel_hi:[1,1,0]
    v_pk_fma_f32 v[176:177], v[168:169], v[176:177], 2.0 op_sel_hi:[1,1,0]
    v_pk_fma_f32 v[178:179], v[170:171], v[178:179], 2.0 op_sel_hi:[1,1,0]
    v_rcp_f32 v172, v172
    v_rcp_f32 v173, v173
    v_rcp_f32 v174, v174
    v_rcp_f32 v175, v175
    v_rcp_f32 v176, v176
    v_rcp_f32 v177, v177
    v_rcp_f32 v178, v178
    v_rcp_f32 v179, v179
    v_pk_fma_f32 v[172:173], v[172:173], -2.0, 1.0 op_sel_hi:[1,0,0]
    v_pk_fma_f32 v[174:175], v[174:175], -2.0, 1.0 op_sel_hi:[1,0,0]
    v_pk_fma_f32 v[176:177], v[176:177], -2.0, 1.0 op_sel_hi:[1,0,0]
    v_pk_fma_f32 v[178:179], v[178:179], -2.0, 1.0 op_sel_hi:[1,0,0]
    v_pk_mul_f32 v[172:173], v[116:117], v[172:173]
    v_pk_mul_f32 v[174:175], v[118:119], v[174:175]
    v_pk_mul_f32 v[176:177], v[128:129], v[176:177]
    v_pk_mul_f32 v[178:179], v[130:131], v[178:179]
    v_cvt_pk_bf16_f32 v180, v172, v173
    v_cvt_pk_bf16_f32 v181, v174, v175
    v_cvt_pk_bf16_f32 v182, v176, v177
    v_cvt_pk_bf16_f32 v183, v178, v179
    s_nop 0
    v_permlane16_swap_b32 v180, v182
    v_permlane16_swap_b32 v181, v183
    s_add_u32 s46, s51, 362496
    buffer_store_dwordx4 v[180:183], v16, s[16:19], s46 offen sc1
L_fused_ffnskip25:
    s_cmp_ge_u32 s44, 82
    s_cbranch_scc1 L_fused_ffnskip26
    v_pk_mul_f32 v[140:141], v[48:49], s[42:43] op_sel_hi:[1,0]
    v_pk_mul_f32 v[142:143], v[50:51], s[42:43] op_sel_hi:[1,0]
    v_pk_mul_f32 v[144:145], v[60:61], s[42:43] op_sel_hi:[1,0]
    v_pk_mul_f32 v[146:147], v[62:63], s[42:43] op_sel_hi:[1,0]
    v_exp_f32 v140, v140
    v_exp_f32 v141, v141
    v_exp_f32 v142, v142
    v_exp_f32 v143, v143
    v_exp_f32 v144, v144
    v_exp_f32 v145, v145
    v_exp_f32 v146, v146
    v_exp_f32 v147, v147
    v_pk_add_f32 v[148:149], v[140:141], 2.0 op_sel_hi:[1,0]
    v_pk_add_f32 v[150:151], v[142:143], 2.0 op_sel_hi:[1,0]
    v_pk_add_f32 v[152:153], v[144:145], 2.0 op_sel_hi:[1,0]
    v_pk_add_f32 v[154:155], v[146:147], 2.0 op_sel_hi:[1,0]
    v_pk_fma_f32 v[148:149], v[140:141], v[148:149], 2.0 op_sel_hi:[1,1,0]
    v_pk_fma_f32 v[150:151], v[142:143], v[150:151], 2.0 op_sel_hi:[1,1,0]
    v_pk_fma_f32 v[152:153], v[144:145], v[152:153], 2.0 op_sel_hi:[1,1,0]
    v_pk_fma_f32 v[154:155], v[146:147], v[154:155], 2.0 op_sel_hi:[1,1,0]
    v_rcp_f32 v148, v148
    v_rcp_f32 v149, v149
    v_rcp_f32 v150, v150
    v_rcp_f32 v151, v151
    v_rcp_f32 v152, v152
    v_rcp_f32 v153, v153
    v_rcp_f32 v154, v154
    v_rcp_f32 v155, v155
    v_pk_fma_f32 v[148:149], v[148:149], -2.0, 1.0 op_sel_hi:[1,0,0]
    v_pk_fma_f32 v[150:151], v[150:151], -2.0, 1.0 op_sel_hi:[1,0,0]
    v_pk_fma_f32 v[152:153], v[152:153], -2.0, 1.0 op_sel_hi:[1,0,0]
    v_pk_fma_f32 v[154:155], v[154:155], -2.0, 1.0 op_sel_hi:[1,0,0]
    v_pk_mul_f32 v[148:149], v[48:49], v[148:149]
    v_pk_mul_f32 v[150:151], v[50:51], v[150:151]
    v_pk_mul_f32 v[152:153], v[60:61], v[152:153]
    v_pk_mul_f32 v[154:155], v[62:63], v[154:155]
    v_cvt_pk_bf16_f32 v156, v148, v149
    v_cvt_pk_bf16_f32 v157, v150, v151
    v_cvt_pk_bf16_f32 v158, v152, v153
    v_cvt_pk_bf16_f32 v159, v154, v155
    s_nop 0
    v_permlane16_swap_b32 v156, v158
    v_permlane16_swap_b32 v157, v159
    s_add_u32 s46, s51, 4096
    buffer_store_dwordx4 v[156:159], v16, s[16:19], s46 offen sc1
    v_pk_mul_f32 v[164:165], v[72:73], s[42:43] op_sel_hi:[1,0]
    v_pk_mul_f32 v[166:167], v[74:75], s[42:43] op_sel_hi:[1,0]
    v_pk_mul_f32 v[168:169], v[84:85], s[42:43] op_sel_hi:[1,0]
    v_pk_mul_f32 v[170:171], v[86:87], s[42:43] op_sel_hi:[1,0]
    v_exp_f32 v164, v164
    v_exp_f32 v165, v165
    v_exp_f32 v166, v166
    v_exp_f32 v167, v167
    v_exp_f32 v168, v168
    v_exp_f32 v169, v169
    v_exp_f32 v170, v170
    v_exp_f32 v171, v171
    v_pk_add_f32 v[172:173], v[164:165], 2.0 op_sel_hi:[1,0]
    v_pk_add_f32 v[174:175], v[166:167], 2.0 op_sel_hi:[1,0]
    v_pk_add_f32 v[176:177], v[168:169], 2.0 op_sel_hi:[1,0]
    v_pk_add_f32 v[178:179], v[170:171], 2.0 op_sel_hi:[1,0]
    v_pk_fma_f32 v[172:173], v[164:165], v[172:173], 2.0 op_sel_hi:[1,1,0]
    v_pk_fma_f32 v[174:175], v[166:167], v[174:175], 2.0 op_sel_hi:[1,1,0]
    v_pk_fma_f32 v[176:177], v[168:169], v[176:177], 2.0 op_sel_hi:[1,1,0]
    v_pk_fma_f32 v[178:179], v[170:171], v[178:179], 2.0 op_sel_hi:[1,1,0]
    v_rcp_f32 v172, v172
    v_rcp_f32 v173, v173
    v_rcp_f32 v174, v174
    v_rcp_f32 v175, v175
    v_rcp_f32 v176, v176
    v_rcp_f32 v177, v177
    v_rcp_f32 v178, v178
    v_rcp_f32 v179, v179
    v_pk_fma_f32 v[172:173], v[172:173], -2.0, 1.0 op_sel_hi:[1,0,0]
    v_pk_fma_f32 v[174:175], v[174:175], -2.0, 1.0 op_sel_hi:[1,0,0]
    v_pk_fma_f32 v[176:177], v[176:177], -2.0, 1.0 op_sel_hi:[1,0,0]
    v_pk_fma_f32 v[178:179], v[178:179], -2.0, 1.0 op_sel_hi:[1,0,0]
    v_pk_mul_f32 v[172:173], v[72:73], v[172:173]
    v_pk_mul_f32 v[174:175], v[74:75], v[174:175]
    v_pk_mul_f32 v[176:177], v[84:85], v[176:177]
    v_pk_mul_f32 v[178:179], v[86:87], v[178:179]
    v_cvt_pk_bf16_f32 v180, v172, v173
    v_cvt_pk_bf16_f32 v181, v174, v175
    v_cvt_pk_bf16_f32 v182, v176, v177
    v_cvt_pk_bf16_f32 v183, v178, v179
    s_nop 0
    v_permlane16_swap_b32 v180, v182
    v_permlane16_swap_b32 v181, v183
    s_add_u32 s46, s51, 124928
    buffer_store_dwordx4 v[180:183], v16, s[16:19], s46 offen sc1
    v_pk_mul_f32 v[140:141], v[96:97], s[42:43] op_sel_hi:[1,0]
    v_pk_mul_f32 v[142:143], v[98:99], s[42:43] op_sel_hi:[1,0]
    v_pk_mul_f32 v[144:145], v[108:109], s[42:43] op_sel_hi:[1,0]
    v_pk_mul_f32 v[146:147], v[110:111], s[42:43] op_sel_hi:[1,0]
    v_exp_f32 v140, v140
    v_exp_f32 v141, v141
    v_exp_f32 v142, v142
    v_exp_f32 v143, v143
    v_exp_f32 v144, v144
    v_exp_f32 v145, v145
    v_exp_f32 v146, v146
    v_exp_f32 v147, v147
    v_pk_add_f32 v[148:149], v[140:141], 2.0 op_sel_hi:[1,0]
    v_pk_add_f32 v[150:151], v[142:143], 2.0 op_sel_hi:[1,0]
    v_pk_add_f32 v[152:153], v[144:145], 2.0 op_sel_hi:[1,0]
    v_pk_add_f32 v[154:155], v[146:147], 2.0 op_sel_hi:[1,0]
    v_pk_fma_f32 v[148:149], v[140:141], v[148:149], 2.0 op_sel_hi:[1,1,0]
    v_pk_fma_f32 v[150:151], v[142:143], v[150:151], 2.0 op_sel_hi:[1,1,0]
    v_pk_fma_f32 v[152:153], v[144:145], v[152:153], 2.0 op_sel_hi:[1,1,0]
    v_pk_fma_f32 v[154:155], v[146:147], v[154:155], 2.0 op_sel_hi:[1,1,0]
    v_rcp_f32 v148, v148
    v_rcp_f32 v149, v149
    v_rcp_f32 v150, v150
    v_rcp_f32 v151, v151
    v_rcp_f32 v152, v152
    v_rcp_f32 v153, v153
    v_rcp_f32 v154, v154
    v_rcp_f32 v155, v155
    v_pk_fma_f32 v[148:149], v[148:149], -2.0, 1.0 op_sel_hi:[1,0,0]
    v_pk_fma_f32 v[150:151], v[150:151], -2.0, 1.0 op_sel_hi:[1,0,0]
    v_pk_fma_f32 v[152:153], v[152:153], -2.0, 1.0 op_sel_hi:[1,0,0]
    v_pk_fma_f32 v[154:155], v[154:155], -2.0, 1.0 op_sel_hi:[1,0,0]
    v_pk_mul_f32 v[148:149], v[96:97], v[148:149]
    v_pk_mul_f32 v[150:151], v[98:99], v[150:151]
    v_pk_mul_f32 v[152:153], v[108:109], v[152:153]
    v_pk_mul_f32 v[154:155], v[110:111], v[154:155]
    v_cvt_pk_bf16_f32 v156, v148, v149
    v_cvt_pk_bf16_f32 v157, v150, v151
    v_cvt_pk_bf16_f32 v158, v152, v153
    v_cvt_pk_bf16_f32 v159, v154, v155
    s_nop 0
    v_permlane16_swap_b32 v156, v158
    v_permlane16_swap_b32 v157, v159
    s_add_u32 s46, s51, 245760
    buffer_store_dwordx4 v[156:159], v16, s[16:19], s46 offen sc1
    v_pk_mul_f32 v[164:165], v[120:121], s[42:43] op_sel_hi:[1,0]
    v_pk_mul_f32 v[166:167], v[122:123], s[42:43] op_sel_hi:[1,0]
    v_pk_mul_f32 v[168:169], v[132:133], s[42:43] op_sel_hi:[1,0]
    v_pk_mul_f32 v[170:171], v[134:135], s[42:43] op_sel_hi:[1,0]
    v_exp_f32 v164, v164
    v_exp_f32 v165, v165
    v_exp_f32 v166, v166
    v_exp_f32 v167, v167
    v_exp_f32 v168, v168
    v_exp_f32 v169, v169
    v_exp_f32 v170, v170
    v_exp_f32 v171, v171
    v_pk_add_f32 v[172:173], v[164:165], 2.0 op_sel_hi:[1,0]
    v_pk_add_f32 v[174:175], v[166:167], 2.0 op_sel_hi:[1,0]
    v_pk_add_f32 v[176:177], v[168:169], 2.0 op_sel_hi:[1,0]
    v_pk_add_f32 v[178:179], v[170:171], 2.0 op_sel_hi:[1,0]
    v_pk_fma_f32 v[172:173], v[164:165], v[172:173], 2.0 op_sel_hi:[1,1,0]
    v_pk_fma_f32 v[174:175], v[166:167], v[174:175], 2.0 op_sel_hi:[1,1,0]
    v_pk_fma_f32 v[176:177], v[168:169], v[176:177], 2.0 op_sel_hi:[1,1,0]
    v_pk_fma_f32 v[178:179], v[170:171], v[178:179], 2.0 op_sel_hi:[1,1,0]
    v_rcp_f32 v172, v172
    v_rcp_f32 v173, v173
    v_rcp_f32 v174, v174
    v_rcp_f32 v175, v175
    v_rcp_f32 v176, v176
    v_rcp_f32 v177, v177
    v_rcp_f32 v178, v178
    v_rcp_f32 v179, v179
    v_pk_fma_f32 v[172:173], v[172:173], -2.0, 1.0 op_sel_hi:[1,0,0]
    v_pk_fma_f32 v[174:175], v[174:175], -2.0, 1.0 op_sel_hi:[1,0,0]
    v_pk_fma_f32 v[176:177], v[176:177], -2.0, 1.0 op_sel_hi:[1,0,0]
    v_pk_fma_f32 v[178:179], v[178:179], -2.0, 1.0 op_sel_hi:[1,0,0]
    v_pk_mul_f32 v[172:173], v[120:121], v[172:173]
    v_pk_mul_f32 v[174:175], v[122:123], v[174:175]
    v_pk_mul_f32 v[176:177], v[132:133], v[176:177]
    v_pk_mul_f32 v[178:179], v[134:135], v[178:179]
    v_cvt_pk_bf16_f32 v180, v172, v173
    v_cvt_pk_bf16_f32 v181, v174, v175
    v_cvt_pk_bf16_f32 v182, v176, v177
    v_cvt_pk_bf16_f32 v183, v178, v179
    s_nop 0
    v_permlane16_swap_b32 v180, v182
    v_permlane16_swap_b32 v181, v183
    s_add_u32 s46, s51, 366592
    buffer_store_dwordx4 v[180:183], v16, s[16:19], s46 offen sc1
L_fused_ffnskip26:
    s_cmp_ge_u32 s44, 78
    s_cbranch_scc1 L_fused_ffnskip27
    v_pk_mul_f32 v[140:141], v[52:53], s[42:43] op_sel_hi:[1,0]
    v_pk_mul_f32 v[142:143], v[54:55], s[42:43] op_sel_hi:[1,0]
    v_pk_mul_f32 v[144:145], v[64:65], s[42:43] op_sel_hi:[1,0]
    v_pk_mul_f32 v[146:147], v[66:67], s[42:43] op_sel_hi:[1,0]
    v_exp_f32 v140, v140
    v_exp_f32 v141, v141
    v_exp_f32 v142, v142
    v_exp_f32 v143, v143
    v_exp_f32 v144, v144
    v_exp_f32 v145, v145
    v_exp_f32 v146, v146
    v_exp_f32 v147, v147
    v_pk_add_f32 v[148:149], v[140:141], 2.0 op_sel_hi:[1,0]
    v_pk_add_f32 v[150:151], v[142:143], 2.0 op_sel_hi:[1,0]
    v_pk_add_f32 v[152:153], v[144:145], 2.0 op_sel_hi:[1,0]
    v_pk_add_f32 v[154:155], v[146:147], 2.0 op_sel_hi:[1,0]
    v_pk_fma_f32 v[148:149], v[140:141], v[148:149], 2.0 op_sel_hi:[1,1,0]
    v_pk_fma_f32 v[150:151], v[142:143], v[150:151], 2.0 op_sel_hi:[1,1,0]
    v_pk_fma_f32 v[152:153], v[144:145], v[152:153], 2.0 op_sel_hi:[1,1,0]
    v_pk_fma_f32 v[154:155], v[146:147], v[154:155], 2.0 op_sel_hi:[1,1,0]
    v_rcp_f32 v148, v148
    v_rcp_f32 v149, v149
    v_rcp_f32 v150, v150
    v_rcp_f32 v151, v151
    v_rcp_f32 v152, v152
    v_rcp_f32 v153, v153
    v_rcp_f32 v154, v154
    v_rcp_f32 v155, v155
    v_pk_fma_f32 v[148:149], v[148:149], -2.0, 1.0 op_sel_hi:[1,0,0]
    v_pk_fma_f32 v[150:151], v[150:151], -2.0, 1.0 op_sel_hi:[1,0,0]
    v_pk_fma_f32 v[152:153], v[152:153], -2.0, 1.0 op_sel_hi:[1,0,0]
    v_pk_fma_f32 v[154:155], v[154:155], -2.0, 1.0 op_sel_hi:[1,0,0]
    v_pk_mul_f32 v[148:149], v[52:53], v[148:149]
    v_pk_mul_f32 v[150:151], v[54:55], v[150:151]
    v_pk_mul_f32 v[152:153], v[64:65], v[152:153]
    v_pk_mul_f32 v[154:155], v[66:67], v[154:155]
    v_cvt_pk_bf16_f32 v156, v148, v149
    v_cvt_pk_bf16_f32 v157, v150, v151
    v_cvt_pk_bf16_f32 v158, v152, v153
    v_cvt_pk_bf16_f32 v159, v154, v155
    s_nop 0
    v_permlane16_swap_b32 v156, v158
    v_permlane16_swap_b32 v157, v159
    s_add_u32 s46, s51, 8192
    buffer_store_dwordx4 v[156:159], v16, s[16:19], s46 offen sc1
    v_pk_mul_f32 v[164:165], v[76:77], s[42:43] op_sel_hi:[1,0]
    v_pk_mul_f32 v[166:167], v[78:79], s[42:43] op_sel_hi:[1,0]
    v_pk_mul_f32 v[168:169], v[88:89], s[42:43] op_sel_hi:[1,0]
    v_pk_mul_f32 v[170:171], v[90:91], s[42:43] op_sel_hi:[1,0]
    v_exp_f32 v164, v164
    v_exp_f32 v165, v165
    v_exp_f32 v166, v166
    v_exp_f32 v167, v167
    v_exp_f32 v168, v168
    v_exp_f32 v169, v169
    v_exp_f32 v170, v170
    v_exp_f32 v171, v171
    v_pk_add_f32 v[172:173], v[164:165], 2.0 op_sel_hi:[1,0]
    v_pk_add_f32 v[174:175], v[166:167], 2.0 op_sel_hi:[1,0]
    v_pk_add_f32 v[176:177], v[168:169], 2.0 op_sel_hi:[1,0]
    v_pk_add_f32 v[178:179], v[170:171], 2.0 op_sel_hi:[1,0]
    v_pk_fma_f32 v[172:173], v[164:165], v[172:173], 2.0 op_sel_hi:[1,1,0]
    v_pk_fma_f32 v[174:175], v[166:167], v[174:175], 2.0 op_sel_hi:[1,1,0]
    v_pk_fma_f32 v[176:177], v[168:169], v[176:177], 2.0 op_sel_hi:[1,1,0]
    v_pk_fma_f32 v[178:179], v[170:171], v[178:179], 2.0 op_sel_hi:[1,1,0]
    v_rcp_f32 v172, v172
    v_rcp_f32 v173, v173
    v_rcp_f32 v174, v174
    v_rcp_f32 v175, v175
    v_rcp_f32 v176, v176
    v_rcp_f32 v177, v177
    v_rcp_f32 v178, v178
    v_rcp_f32 v179, v179
    v_pk_fma_f32 v[172:173], v[172:173], -2.0, 1.0 op_sel_hi:[1,0,0]
    v_pk_fma_f32 v[174:175], v[174:175], -2.0, 1.0 op_sel_hi:[1,0,0]
    v_pk_fma_f32 v[176:177], v[176:177], -2.0, 1.0 op_sel_hi:[1,0,0]
    v_pk_fma_f32 v[178:179], v[178:179], -2.0, 1.0 op_sel_hi:[1,0,0]
    v_pk_mul_f32 v[172:173], v[76:77], v[172:173]
    v_pk_mul_f32 v[174:175], v[78:79], v[174:175]
    v_pk_mul_f32 v[176:177], v[88:89], v[176:177]
    v_pk_mul_f32 v[178:179], v[90:91], v[178:179]
    v_cvt_pk_bf16_f32 v180, v172, v173
    v_cvt_pk_bf16_f32 v181, v174, v175
    v_cvt_pk_bf16_f32 v182, v176, v177
    v_cvt_pk_bf16_f32 v183, v178, v179
    s_nop 0
    v_permlane16_swap_b32 v180, v182
    v_permlane16_swap_b32 v181, v183
    s_add_u32 s46, s51, 129024
    buffer_store_dwordx4 v[180:183], v16, s[16:19], s46 offen sc1
    v_pk_mul_f32 v[140:141], v[100:101], s[42:43] op_sel_hi:[1,0]
    v_pk_mul_f32 v[142:143], v[102:103], s[42:43] op_sel_hi:[1,0]
    v_pk_mul_f32 v[144:145], v[112:113], s[42:43] op_sel_hi:[1,0]
    v_pk_mul_f32 v[146:147], v[114:115], s[42:43] op_sel_hi:[1,0]
    v_exp_f32 v140, v140
    v_exp_f32 v141, v141
    v_exp_f32 v142, v142
    v_exp_f32 v143, v143
    v_exp_f32 v144, v144
    v_exp_f32 v145, v145
    v_exp_f32 v146, v146
    v_exp_f32 v147, v147
    v_pk_add_f32 v[148:149], v[140:141], 2.0 op_sel_hi:[1,0]
    v_pk_add_f32 v[150:151], v[142:143], 2.0 op_sel_hi:[1,0]
    v_pk_add_f32 v[152:153], v[144:145], 2.0 op_sel_hi:[1,0]
    v_pk_add_f32 v[154:155], v[146:147], 2.0 op_sel_hi:[1,0]
    v_pk_fma_f32 v[148:149], v[140:141], v[148:149], 2.0 op_sel_hi:[1,1,0]
    v_pk_fma_f32 v[150:151], v[142:143], v[150:151], 2.0 op_sel_hi:[1,1,0]
    v_pk_fma_f32 v[152:153], v[144:145], v[152:153], 2.0 op_sel_hi:[1,1,0]
    v_pk_fma_f32 v[154:155], v[146:147], v[154:155], 2.0 op_sel_hi:[1,1,0]
    v_rcp_f32 v148, v148
    v_rcp_f32 v149, v149
    v_rcp_f32 v150, v150
    v_rcp_f32 v151, v151
    v_rcp_f32 v152, v152
    v_rcp_f32 v153, v153
    v_rcp_f32 v154, v154
    v_rcp_f32 v155, v155
    v_pk_fma_f32 v[148:149], v[148:149], -2.0, 1.0 op_sel_hi:[1,0,0]
    v_pk_fma_f32 v[150:151], v[150:151], -2.0, 1.0 op_sel_hi:[1,0,0]
    v_pk_fma_f32 v[152:153], v[152:153], -2.0, 1.0 op_sel_hi:[1,0,0]
    v_pk_fma_f32 v[154:155], v[154:155], -2.0, 1.0 op_sel_hi:[1,0,0]
    v_pk_mul_f32 v[148:149], v[100:101], v[148:149]
    v_pk_mul_f32 v[150:151], v[102:103], v[150:151]
    v_pk_mul_f32 v[152:153], v[112:113], v[152:153]
    v_pk_mul_f32 v[154:155], v[114:115], v[154:155]
    v_cvt_pk_bf16_f32 v156, v148, v149
    v_cvt_pk_bf16_f32 v157, v150, v151
    v_cvt_pk_bf16_f32 v158, v152, v153
    v_cvt_pk_bf16_f32 v159, v154, v155
    s_nop 0
    v_permlane16_swap_b32 v156, v158
    v_permlane16_swap_b32 v157, v159
    s_add_u32 s46, s51, 249856
    buffer_store_dwordx4 v[156:159], v16, s[16:19], s46 offen sc1
    v_pk_mul_f32 v[164:165], v[124:125], s[42:43] op_sel_hi:[1,0]
    v_pk_mul_f32 v[166:167], v[126:127], s[42:43] op_sel_hi:[1,0]
    v_pk_mul_f32 v[168:169], v[136:137], s[42:43] op_sel_hi:[1,0]
    v_pk_mul_f32 v[170:171], v[138:139], s[42:43] op_sel_hi:[1,0]
    v_exp_f32 v164, v164
    v_exp_f32 v165, v165
    v_exp_f32 v166, v166
    v_exp_f32 v167, v167
    v_exp_f32 v168, v168
    v_exp_f32 v169, v169
    v_exp_f32 v170, v170
    v_exp_f32 v171, v171
    v_pk_add_f32 v[172:173], v[164:165], 2.0 op_sel_hi:[1,0]
    v_pk_add_f32 v[174:175], v[166:167], 2.0 op_sel_hi:[1,0]
    v_pk_add_f32 v[176:177], v[168:169], 2.0 op_sel_hi:[1,0]
    v_pk_add_f32 v[178:179], v[170:171], 2.0 op_sel_hi:[1,0]
    v_pk_fma_f32 v[172:173], v[164:165], v[172:173], 2.0 op_sel_hi:[1,1,0]
    v_pk_fma_f32 v[174:175], v[166:167], v[174:175], 2.0 op_sel_hi:[1,1,0]
    v_pk_fma_f32 v[176:177], v[168:169], v[176:177], 2.0 op_sel_hi:[1,1,0]
    v_pk_fma_f32 v[178:179], v[170:171], v[178:179], 2.0 op_sel_hi:[1,1,0]
    v_rcp_f32 v172, v172
    v_rcp_f32 v173, v173
    v_rcp_f32 v174, v174
    v_rcp_f32 v175, v175
    v_rcp_f32 v176, v176
    v_rcp_f32 v177, v177
    v_rcp_f32 v178, v178
    v_rcp_f32 v179, v179
    v_pk_fma_f32 v[172:173], v[172:173], -2.0, 1.0 op_sel_hi:[1,0,0]
    v_pk_fma_f32 v[174:175], v[174:175], -2.0, 1.0 op_sel_hi:[1,0,0]
    v_pk_fma_f32 v[176:177], v[176:177], -2.0, 1.0 op_sel_hi:[1,0,0]
    v_pk_fma_f32 v[178:179], v[178:179], -2.0, 1.0 op_sel_hi:[1,0,0]
    v_pk_mul_f32 v[172:173], v[124:125], v[172:173]
    v_pk_mul_f32 v[174:175], v[126:127], v[174:175]
    v_pk_mul_f32 v[176:177], v[136:137], v[176:177]
    v_pk_mul_f32 v[178:179], v[138:139], v[178:179]
    v_cvt_pk_bf16_f32 v180, v172, v173
    v_cvt_pk_bf16_f32 v181, v174, v175
    v_cvt_pk_bf16_f32 v182, v176, v177
    v_cvt_pk_bf16_f32 v183, v178, v179
    s_nop 0
    v_permlane16_swap_b32 v180, v182
    v_permlane16_swap_b32 v181, v183
    s_add_u32 s46, s51, 370688
    buffer_store_dwordx4 v[180:183], v16, s[16:19], s46 offen sc1
L_fused_ffnskip27:
L_fused_epidone:
    s_barrier
    s_lshl_b32 s38, s3, 11
    s_sub_u32 s38, s38, s61
    v_add_u32 v20, s38, v17
    v_xor_b32 v21, 64, v20
    v_add_u32 v22, 0x10000, v20
    v_add_u32 v23, 0x10000, v21
    v_add_u32 v24, 0x20000, v20
    v_add_u32 v25, 0x20000, v21
    ds_read_b64_tr_b16 v[128:129], v24 offset:17408
    ds_read_b64_tr_b16 v[130:131], v24 offset:17920
    ds_read_b64_tr_b16 v[132:133], v25 offset:17408
    ds_read_b64_tr_b16 v[134:135], v25 offset:17920
    ds_read_b64_tr_b16 v[136:137], v20 offset:49152
    ds_read_b64_tr_b16 v[138:139], v20 offset:49664
    ds_read_b64_tr_b16 v[140:141], v21 offset:49152
    ds_read_b64_tr_b16 v[142:143], v21 offset:49664
    ds_read_b64_tr_b16 v[144:145], v22 offset:8192
    ds_read_b64_tr_b16 v[146:147], v22 offset:8704
    ds_read_b64_tr_b16 v[148:149], v23 offset:8192
    ds_read_b64_tr_b16 v[150:151], v23 offset:8704
    s_waitcnt lgkmcnt(4)
    ds_read_b64_tr_b16 v[152:153], v22 offset:16384
    ds_read_b64_tr_b16 v[154:155], v22 offset:16896
    ds_read_b64_tr_b16 v[156:157], v23 offset:16384
    ds_read_b64_tr_b16 v[158:159], v23 offset:16896
    ds_read_b64_tr_b16 v[160:161], v20 offset:57344
    ds_read_b64_tr_b16 v[162:163], v20 offset:57856
    ds_read_b64_tr_b16 v[164:165], v21 offset:57344
    ds_read_b64_tr_b16 v[166:167], v21 offset:57856
    ds_read_b64_tr_b16 v[168:169], v22 offset:0
    ds_read_b64_tr_b16 v[170:171], v22 offset:512
    ds_read_b64_tr_b16 v[172:173], v23 offset:0
    ds_read_b64_tr_b16 v[174:175], v23 offset:512
    s_waitcnt lgkmcnt(4)
    ds_read_b64_tr_b16 v[176:177], v20 offset:0
    ds_read_b64_tr_b16 v[178:179], v20 offset:512
    ds_read_b64_tr_b16 v[180:181], v21 offset:0
    ds_read_b64_tr_b16 v[182:183], v21 offset:512
    ds_read_b64_tr_b16 v[184:185], v22 offset:24576
    ds_read_b64_tr_b16 v[186:187], v22 offset:25088
    ds_read_b64_tr_b16 v[188:189], v23 offset:24576
    ds_read_b64_tr_b16 v[190:191], v23 offset:25088
    ds_read_b64_tr_b16 v[192:193], v22 offset:32768
    ds_read_b64_tr_b16 v[194:195], v22 offset:33280
    ds_read_b64_tr_b16 v[196:197], v23 offset:32768
    ds_read_b64_tr_b16 v[198:199], v23 offset:33280
    s_waitcnt lgkmcnt(4)
    ds_read_b64_tr_b16 v[200:201], v20 offset:8192
    ds_read_b64_tr_b16 v[202:203], v20 offset:8704
    ds_read_b64_tr_b16 v[204:205], v21 offset:8192
    ds_read_b64_tr_b16 v[206:207], v21 offset:8704
    ds_read_b64_tr_b16 v[208:209], v20 offset:16384
    ds_read_b64_tr_b16 v[210:211], v20 offset:16896
    ds_read_b64_tr_b16 v[212:213], v21 offset:16384
    ds_read_b64_tr_b16 v[214:215], v21 offset:16896
    ds_read_b64_tr_b16 v[216:217], v20 offset:24576
    ds_read_b64_tr_b16 v[218:219], v20 offset:25088
    ds_read_b64_tr_b16 v[220:221], v21 offset:24576
    ds_read_b64_tr_b16 v[222:223], v21 offset:25088
    s_waitcnt lgkmcnt(4)
    ds_read_b64_tr_b16 v[224:225], v22 offset:40960
    ds_read_b64_tr_b16 v[226:227], v22 offset:41472
    ds_read_b64_tr_b16 v[228:229], v23 offset:40960
    ds_read_b64_tr_b16 v[230:231], v23 offset:41472
    ds_read_b64_tr_b16 v[232:233], v22 offset:49152
    ds_read_b64_tr_b16 v[234:235], v22 offset:49664
    ds_read_b64_tr_b16 v[236:237], v23 offset:49152
    ds_read_b64_tr_b16 v[238:239], v23 offset:49664
    ds_read_b64_tr_b16 v[240:241], v20 offset:32768
    ds_read_b64_tr_b16 v[242:243], v20 offset:33280
    ds_read_b64_tr_b16 v[244:245], v21 offset:32768
    ds_read_b64_tr_b16 v[246:247], v21 offset:33280
    s_waitcnt lgkmcnt(4)
    ds_read_b64_tr_b16 v[248:249], v20 offset:40960
    ds_read_b64_tr_b16 v[250:251], v20 offset:41472
    ds_read_b64_tr_b16 v[252:253], v21 offset:40960
    ds_read_b64_tr_b16 v[254:255], v21 offset:41472
    s_waitcnt lgkmcnt(0)
    s_barrier
    s_waitcnt vmcnt(0)
L_fused_nre29:
    v_readfirstlane_b32 s53, v9
    s_cmp_lg_u32 s53, 0
    s_cbranch_scc1 L_fused_nok30
    v_mov_b32 v4, 0
    global_load_dword v9, v4, s[28:29] sc1
    s_waitcnt vmcnt(0)
    s_branch L_fused_nre29
L_fused_nok30:
    v_mov_b32 v4, 147456
    v_mov_b32 v5, 1
    s_mov_b64 exec, 1
    ds_add_rtn_u32 v6, v4, v5
    s_waitcnt lgkmcnt(0)
    s_mov_b64 exec, -1
    v_readfirstlane_b32 s38, v6
    s_cmp_lg_u32 s38, 3
    s_cbranch_scc1 L_fused_nosig28
    s_lshl_b32 s38, s33, 11
    s_lshl_b32 s39, s34, 2
    s_add_u32 s46, s38, s39
    s_add_u32 s46, s46, 7929856
    v_lshlrev_b32 v4, 7, v2
    v_mov_b32 v5, s53
    s_mov_b64 exec, 0xffff
    buffer_store_dword v5, v4, s[16:19], s46 offen sc1
    s_mov_b64 exec, -1
L_fused_nosig28:
    s_lshl_b32 s38, s40, 3
    s_add_u32 s38, s38, s41
    s_lshl_b32 s38, s38, 7
    s_add_u32 s46, s38, 7929856
    s_lshl_b32 s38, s3, 1
    s_add_u32 s38, s38, 6
    s_lshl_b32 s39, 7, s38
    s_cmp_eq_u32 s3, 3
    s_cselect_b32 s38, 0x8000, 0
    s_or_b32 s39, s39, s38
    s_cmp_eq_u32 s3, 0
    s_cselect_b32 s39, 0xff, s39
    v_lshlrev_b32 v4, 2, v2
    s_mov_b64 exec, 0xffff

L_fused_poll31:
    buffer_load_dword v3, v4, s[16:19], s46 offen sc1
    s_waitcnt vmcnt(0)
    v_cmp_ne_u32 vcc, s53, v3
    s_nop 3
    s_and_b32 s38, vcc_lo, s39
    s_cmp_eq_u32 s38, 0
    s_cbranch_scc1 L_fused_pok32
    s_sleep 6
    s_branch L_fused_poll31
L_fused_pok32:
    s_mov_b64 exec, 1
    s_lshl_b32 s38, s3, 2
    s_add_u32 s38, s38, 147456
    v_mov_b32 v4, s38
    v_mov_b32 v5, 1
    ds_write_b32 v4, v5 offset:32
    v_mov_b32 v4, 147456
    ds_add_u32 v4, v5 offset:4
    s_mov_b64 exec, -1
L_fused_phase2:
    s_mov_b32 s59, s57
    s_add_u32 s46, s62, 0
    buffer_load_dwordx4 v[64:67], v16, s[16:19], s46 offen sc1
    s_add_u32 s46, s62, 1024
    buffer_load_dwordx4 v[68:71], v16, s[16:19], s46 offen sc1
    s_add_u32 s46, s62, 2048
    buffer_load_dwordx4 v[72:75], v16, s[16:19], s46 offen sc1
    s_add_u32 s46, s62, 3072
    buffer_load_dwordx4 v[76:79], v16, s[16:19], s46 offen sc1
    s_add_u32 s46, s62, 4096
    buffer_load_dwordx4 v[80:83], v16, s[16:19], s46 offen sc1
    s_add_u32 s46, s62, 5120
    buffer_load_dwordx4 v[84:87], v16, s[16:19], s46 offen sc1
    s_add_u32 s46, s62, 6144
    buffer_load_dwordx4 v[88:91], v16, s[16:19], s46 offen sc1
    s_add_u32 s46, s62, 7168
    buffer_load_dwordx4 v[92:95], v16, s[16:19], s46 offen sc1
    s_add_u32 s46, s62, 8192
    buffer_load_dwordx4 v[96:99], v16, s[16:19], s46 offen sc1
    s_add_u32 s46, s62, 9216
    buffer_load_dwordx4 v[100:103], v16, s[16:19], s46 offen sc1
    s_add_u32 s46, s62, 10240
    buffer_load_dwordx4 v[104:107], v16, s[16:19], s46 offen sc1
    s_add_u32 s46, s62, 11264
    buffer_load_dwordx4 v[108:111], v16, s[16:19], s46 offen sc1
    s_waitcnt vmcnt(11)
    s_cmp_lt_u32 s30, 4
    s_cbranch_scc1 L_fused_nold33
    s_lshl_b32 s38, s3, 2
    s_add_u32 s38, s38, 147464
    v_mov_b32 v4, s38
    v_mov_b32 v5, 1
    ds_write_b32 v4, v5
L_fused_nold33:
    v_mfma_f32_32x32x16_bf16 v[32:47], v[128:131], v[64:67], 0
    v_mfma_f32_32x32x16_bf16 v[48:63], v[132:135], v[64:67], 0
    s_add_u32 s46, s62, 12288
    buffer_load_dwordx4 v[64:67], v16, s[16:19], s46 offen sc1
    s_waitcnt vmcnt(11)
    v_mfma_f32_32x32x16_bf16 v[32:47], v[136:139], v[68:71], v[32:47]
    v_mfma_f32_32x32x16_bf16 v[48:63], v[140:143], v[68:71], v[48:63]
    s_add_u32 s46, s62, 13312
    buffer_load_dwordx4 v[68:71], v16, s[16:19], s46 offen sc1
    s_waitcnt vmcnt(11)
    v_mfma_f32_32x32x16_bf16 v[32:47], v[144:147], v[72:75], v[32:47]
    v_mfma_f32_32x32x16_bf16 v[48:63], v[148:151], v[72:75], v[48:63]
    s_add_u32 s46, s62, 14336
    buffer_load_dwordx4 v[72:75], v16, s[16:19], s46 offen sc1
    s_waitcnt vmcnt(11)
    v_mfma_f32_32x32x16_bf16 v[32:47], v[152:155], v[76:79], v[32:47]
    v_mfma_f32_32x32x16_bf16 v[48:63], v[156:159], v[76:79], v[48:63]
    s_add_u32 s46, s62, 15360
    buffer_load_dwordx4 v[76:79], v16, s[16:19], s46 offen sc1
    s_waitcnt vmcnt(11)
    v_mfma_f32_32x32x16_bf16 v[32:47], v[160:163], v[80:83], v[32:47]
    v_mfma_f32_32x32x16_bf16 v[48:63], v[164:167], v[80:83], v[48:63]
    s_add_u32 s46, s62, 16384
    buffer_load_dwordx4 v[80:83], v16, s[16:19], s46 offen sc1
    s_waitcnt vmcnt(11)
    v_mfma_f32_32x32x16_bf16 v[32:47], v[168:171], v[84:87], v[32:47]
    v_mfma_f32_32x32x16_bf16 v[48:63], v[172:175], v[84:87], v[48:63]
    s_add_u32 s46, s62, 17408
    buffer_load_dwordx4 v[84:87], v16, s[16:19], s46 offen sc1
    s_waitcnt vmcnt(11)
    v_mfma_f32_32x32x16_bf16 v[32:47], v[176:179], v[88:91], v[32:47]
    v_mfma_f32_32x32x16_bf16 v[48:63], v[180:183], v[88:91], v[48:63]
    s_add_u32 s46, s62, 18432
    buffer_load_dwordx4 v[88:91], v16, s[16:19], s46 offen sc1
    s_waitcnt vmcnt(11)
    v_mfma_f32_32x32x16_bf16 v[32:47], v[184:187], v[92:95], v[32:47]
    v_mfma_f32_32x32x16_bf16 v[48:63], v[188:191], v[92:95], v[48:63]
    s_add_u32 s46, s62, 19456
    buffer_load_dwordx4 v[92:95], v16, s[16:19], s46 offen sc1
    s_waitcnt vmcnt(11)
    v_mfma_f32_32x32x16_bf16 v[32:47], v[192:195], v[96:99], v[32:47]
    v_mfma_f32_32x32x16_bf16 v[48:63], v[196:199], v[96:99], v[48:63]
    s_add_u32 s46, s62, 20480
    buffer_load_dwordx4 v[96:99], v16, s[16:19], s46 offen sc1
    s_waitcnt vmcnt(11)
    v_mfma_f32_32x32x16_bf16 v[32:47], v[200:203], v[100:103], v[32:47]
    v_mfma_f32_32x32x16_bf16 v[48:63], v[204:207], v[100:103], v[48:63]
    s_add_u32 s46, s62, 21504
    buffer_load_dwordx4 v[100:103], v16, s[16:19], s46 offen sc1
    s_waitcnt vmcnt(11)
    v_mfma_f32_32x32x16_bf16 v[32:47], v[208:211], v[104:107], v[32:47]
    v_mfma_f32_32x32x16_bf16 v[48:63], v[212:215], v[104:107], v[48:63]
    s_add_u32 s46, s62, 22528
    buffer_load_dwordx4 v[104:107], v16, s[16:19], s46 offen sc1
    s_waitcnt vmcnt(11)
    v_mfma_f32_32x32x16_bf16 v[32:47], v[216:219], v[108:111], v[32:47]
    v_mfma_f32_32x32x16_bf16 v[48:63], v[220:223], v[108:111], v[48:63]
    s_add_u32 s46, s62, 23552
    buffer_load_dwordx4 v[108:111], v16, s[16:19], s46 offen sc1
    s_waitcnt vmcnt(11)
    v_mfma_f32_32x32x16_bf16 v[32:47], v[224:227], v[64:67], v[32:47]
    v_mfma_f32_32x32x16_bf16 v[48:63], v[228:231], v[64:67], v[48:63]
    s_add_u32 s46, s62, 24576
    buffer_load_dwordx4 v[64:67], v16, s[16:19], s46 offen sc1
    s_waitcnt vmcnt(11)
    v_mfma_f32_32x32x16_bf16 v[32:47], v[232:235], v[68:71], v[32:47]
    v_mfma_f32_32x32x16_bf16 v[48:63], v[236:239], v[68:71], v[48:63]
    s_add_u32 s46, s62, 25600
    buffer_load_dwordx4 v[68:71], v16, s[16:19], s46 offen sc1
    s_waitcnt vmcnt(11)
    v_mfma_f32_32x32x16_bf16 v[32:47], v[240:243], v[72:75], v[32:47]
    v_mfma_f32_32x32x16_bf16 v[48:63], v[244:247], v[72:75], v[48:63]
    s_add_u32 s46, s62, 26624
    buffer_load_dwordx4 v[72:75], v16, s[16:19], s46 offen sc1
    s_lshl_b32 s38, s3, 2
    s_add_u32 s38, s38, 147464
    v_mov_b32 v6, s38
L_fused_spin34:
    ds_read_b32 v3, v6
    s_waitcnt lgkmcnt(0)
    v_readfirstlane_b32 s38, v3
    s_cmp_lt_u32 s38, 1
    s_cbranch_scc1 L_fused_spin34
    s_waitcnt vmcnt(11)
    v_mfma_f32_32x32x16_bf16 v[32:47], v[248:251], v[76:79], v[32:47]
    ds_read_b64_tr_b16 v[112:113], v17 offset:0
    ds_read_b64_tr_b16 v[114:115], v17 offset:512
    ds_read_b64_tr_b16 v[116:117], v18 offset:0
    ds_read_b64_tr_b16 v[118:119], v18 offset:512
    v_mfma_f32_32x32x16_bf16 v[48:63], v[252:255], v[76:79], v[48:63]
    s_add_u32 s46, s62, 27648
    buffer_load_dwordx4 v[76:79], v16, s[16:19], s46 offen sc1
    s_waitcnt vmcnt(11) lgkmcnt(0)
    v_mfma_f32_32x32x16_bf16 v[32:47], v[112:115], v[80:83], v[32:47]
    ds_read_b64_tr_b16 v[120:121], v17 offset:2048
    ds_read_b64_tr_b16 v[122:123], v17 offset:2560
    ds_read_b64_tr_b16 v[124:125], v18 offset:2048
    ds_read_b64_tr_b16 v[126:127], v18 offset:2560
    v_mfma_f32_32x32x16_bf16 v[48:63], v[116:119], v[80:83], v[48:63]
    s_add_u32 s46, s62, 28672
    s_cmp_ge_u32 s3, 3
    s_cselect_b32 s46, 0x7ff00000, s46
    buffer_load_dwordx4 v[80:83], v16, s[16:19], s46 offen sc1
    s_waitcnt vmcnt(11) lgkmcnt(0)
    v_mfma_f32_32x32x16_bf16 v[32:47], v[120:123], v[84:87], v[32:47]
    ds_read_b64_tr_b16 v[112:113], v17 offset:4096
    ds_read_b64_tr_b16 v[114:115], v17 offset:4608
    ds_read_b64_tr_b16 v[116:117], v18 offset:4096
    ds_read_b64_tr_b16 v[118:119], v18 offset:4608
    v_mfma_f32_32x32x16_bf16 v[48:63], v[124:127], v[84:87], v[48:63]
    s_add_u32 s46, s62, 29696
    s_cmp_ge_u32 s3, 1
    s_cselect_b32 s46, 0x7ff00000, s46
    buffer_load_dwordx4 v[84:87], v16, s[16:19], s46 offen sc1
    s_waitcnt vmcnt(11) lgkmcnt(0)
    v_mfma_f32_32x32x16_bf16 v[32:47], v[112:115], v[88:91], v[32:47]
    ds_read_b64_tr_b16 v[120:121], v17 offset:6144
    ds_read_b64_tr_b16 v[122:123], v17 offset:6656
    ds_read_b64_tr_b16 v[124:125], v18 offset:6144
    ds_read_b64_tr_b16 v[126:127], v18 offset:6656
    v_mfma_f32_32x32x16_bf16 v[48:63], v[116:119], v[88:91], v[48:63]
    s_add_u32 s46, s62, 30720
    s_cmp_ge_u32 s3, 1
    s_cselect_b32 s46, 0x7ff00000, s46
    buffer_load_dwordx4 v[88:91], v16, s[16:19], s46 offen sc1
    s_waitcnt vmcnt(11) lgkmcnt(0)
    v_mfma_f32_32x32x16_bf16 v[32:47], v[120:123], v[92:95], v[32:47]
    ds_read_b64_tr_b16 v[112:113], v17 offset:8192
    ds_read_b64_tr_b16 v[114:115], v17 offset:8704
    ds_read_b64_tr_b16 v[116:117], v18 offset:8192
    ds_read_b64_tr_b16 v[118:119], v18 offset:8704
    v_mfma_f32_32x32x16_bf16 v[48:63], v[124:127], v[92:95], v[48:63]
    s_add_u32 s46, s62, 31744
    s_cmp_ge_u32 s3, 1
    s_cselect_b32 s46, 0x7ff00000, s46
    buffer_load_dwordx4 v[92:95], v16, s[16:19], s46 offen sc1
    v_mov_b32 v6, 147460
L_fused_spin35:
    ds_read_b32 v3, v6
    s_waitcnt lgkmcnt(0)
    v_readfirstlane_b32 s38, v3
    s_cmp_lt_u32 s38, 4
    s_cbranch_scc1 L_fused_spin35
    s_lshr_b32 s38, s30, 2
    s_lshl_b32 s39, s40, 1
    s_add_u32 s39, s39, s38
    s_lshl_b32 s46, s39, 7
    s_add_u32 s46, s46, 7864320
    v_and_b32 v3, 31, v2
    v_lshlrev_b32 v3, 2, v3
    buffer_load_dword v19, v3, s[16:19], s46 offen sc1
    s_waitcnt vmcnt(12) lgkmcnt(0)
    v_mfma_f32_32x32x16_bf16 v[32:47], v[112:115], v[96:99], v[32:47]
    ds_read_b64_tr_b16 v[120:121], v17 offset:10240
    ds_read_b64_tr_b16 v[122:123], v17 offset:10752
    ds_read_b64_tr_b16 v[124:125], v18 offset:10240
    ds_read_b64_tr_b16 v[126:127], v18 offset:10752
    v_mfma_f32_32x32x16_bf16 v[48:63], v[116:119], v[96:99], v[48:63]
    s_waitcnt vmcnt(11) lgkmcnt(0)
    v_mfma_f32_32x32x16_bf16 v[32:47], v[120:123], v[100:103], v[32:47]
    ds_read_b64_tr_b16 v[112:113], v17 offset:12288
    ds_read_b64_tr_b16 v[114:115], v17 offset:12800
    ds_read_b64_tr_b16 v[116:117], v18 offset:12288
    ds_read_b64_tr_b16 v[118:119], v18 offset:12800
    v_mfma_f32_32x32x16_bf16 v[48:63], v[124:127], v[100:103], v[48:63]
    s_waitcnt vmcnt(10) lgkmcnt(0)
    v_mfma_f32_32x32x16_bf16 v[32:47], v[112:115], v[104:107], v[32:47]
    ds_read_b64_tr_b16 v[120:121], v17 offset:14336
    ds_read_b64_tr_b16 v[122:123], v17 offset:14848
    ds_read_b64_tr_b16 v[124:125], v18 offset:14336
    ds_read_b64_tr_b16 v[126:127], v18 offset:14848
    v_mfma_f32_32x32x16_bf16 v[48:63], v[116:119], v[104:107], v[48:63]
    s_waitcnt vmcnt(9) lgkmcnt(0)
    v_mfma_f32_32x32x16_bf16 v[32:47], v[120:123], v[108:111], v[32:47]
    ds_read_b64_tr_b16 v[112:113], v17 offset:16384
    ds_read_b64_tr_b16 v[114:115], v17 offset:16896
    ds_read_b64_tr_b16 v[116:117], v18 offset:16384
    ds_read_b64_tr_b16 v[118:119], v18 offset:16896
    v_mfma_f32_32x32x16_bf16 v[48:63], v[124:127], v[108:111], v[48:63]
    s_waitcnt vmcnt(8) lgkmcnt(0)
    v_mfma_f32_32x32x16_bf16 v[32:47], v[112:115], v[64:67], v[32:47]
    ds_read_b64_tr_b16 v[120:121], v17 offset:18432
    ds_read_b64_tr_b16 v[122:123], v17 offset:18944
    ds_read_b64_tr_b16 v[124:125], v18 offset:18432
    ds_read_b64_tr_b16 v[126:127], v18 offset:18944
    v_mfma_f32_32x32x16_bf16 v[48:63], v[116:119], v[64:67], v[48:63]
    s_waitcnt vmcnt(7) lgkmcnt(0)
    v_mfma_f32_32x32x16_bf16 v[32:47], v[120:123], v[68:71], v[32:47]
    ds_read_b64_tr_b16 v[112:113], v17 offset:20480
    ds_read_b64_tr_b16 v[114:115], v17 offset:20992
    ds_read_b64_tr_b16 v[116:117], v18 offset:20480
    ds_read_b64_tr_b16 v[118:119], v18 offset:20992
    v_mfma_f32_32x32x16_bf16 v[48:63], v[124:127], v[68:71], v[48:63]
    s_waitcnt vmcnt(6) lgkmcnt(0)
    v_mfma_f32_32x32x16_bf16 v[32:47], v[112:115], v[72:75], v[32:47]
    ds_read_b64_tr_b16 v[120:121], v17 offset:22528
    ds_read_b64_tr_b16 v[122:123], v17 offset:23040
    ds_read_b64_tr_b16 v[124:125], v18 offset:22528
    ds_read_b64_tr_b16 v[126:127], v18 offset:23040
    v_mfma_f32_32x32x16_bf16 v[48:63], v[116:119], v[72:75], v[48:63]
    s_waitcnt vmcnt(5) lgkmcnt(0)
    v_mfma_f32_32x32x16_bf16 v[32:47], v[120:123], v[76:79], v[32:47]
    ds_read_b64_tr_b16 v[112:113], v17 offset:24576
    ds_read_b64_tr_b16 v[114:115], v17 offset:25088
    ds_read_b64_tr_b16 v[116:117], v18 offset:24576
    ds_read_b64_tr_b16 v[118:119], v18 offset:25088
    v_mfma_f32_32x32x16_bf16 v[48:63], v[124:127], v[76:79], v[48:63]
    s_cmp_ge_u32 s3, 3
    s_cbranch_scc1 L_fused_p2done0
    s_waitcnt vmcnt(4) lgkmcnt(0)
    v_mfma_f32_32x32x16_bf16 v[32:47], v[112:115], v[80:83], v[32:47]
    ds_read_b64_tr_b16 v[120:121], v17 offset:26624
    ds_read_b64_tr_b16 v[122:123], v17 offset:27136
    ds_read_b64_tr_b16 v[124:125], v18 offset:26624
    ds_read_b64_tr_b16 v[126:127], v18 offset:27136
    v_mfma_f32_32x32x16_bf16 v[48:63], v[116:119], v[80:83], v[48:63]
    s_cmp_ge_u32 s3, 1
    s_cbranch_scc1 L_fused_p2done0
    s_waitcnt vmcnt(3) lgkmcnt(0)
    v_mfma_f32_32x32x16_bf16 v[32:47], v[120:123], v[84:87], v[32:47]
    ds_read_b64_tr_b16 v[112:113], v17 offset:28672
    ds_read_b64_tr_b16 v[114:115], v17 offset:29184
    ds_read_b64_tr_b16 v[116:117], v18 offset:28672
    ds_read_b64_tr_b16 v[118:119], v18 offset:29184
    v_mfma_f32_32x32x16_bf16 v[48:63], v[124:127], v[84:87], v[48:63]
    s_waitcnt vmcnt(2) lgkmcnt(0)
    v_mfma_f32_32x32x16_bf16 v[32:47], v[112:115], v[88:91], v[32:47]
    ds_read_b64_tr_b16 v[120:121], v17 offset:30720
    ds_read_b64_tr_b16 v[122:123], v17 offset:31232
    ds_read_b64_tr_b16 v[124:125], v18 offset:30720
    ds_read_b64_tr_b16 v[126:127], v18 offset:31232
    v_mfma_f32_32x32x16_bf16 v[48:63], v[116:119], v[88:91], v[48:63]
    s_waitcnt vmcnt(1) lgkmcnt(0)
    v_mfma_f32_32x32x16_bf16 v[32:47], v[120:123], v[92:95], v[32:47]
    v_mfma_f32_32x32x16_bf16 v[48:63], v[124:127], v[92:95], v[48:63]
L_fused_p2done0:
    s_waitcnt vmcnt(0) lgkmcnt(0)
    v_sub_f32 v3, 1.0, v19
    s_cmp_eq_u32 s3, 0
    s_cselect_b64 vcc, -1, 0
    s_nop 1
    v_cndmask_b32 v19, v3, v19, vcc
    s_nop 7
    v_mul_f32 v32, v32, v19
    v_mul_f32 v33, v33, v19
    v_mul_f32 v34, v34, v19
    v_mul_f32 v35, v35, v19
    v_mul_f32 v36, v36, v19
    v_mul_f32 v37, v37, v19
    v_mul_f32 v38, v38, v19
    v_mul_f32 v39, v39, v19
    v_mul_f32 v40, v40, v19
    v_mul_f32 v41, v41, v19
    v_mul_f32 v42, v42, v19
    v_mul_f32 v43, v43, v19
    v_mul_f32 v44, v44, v19
    v_mul_f32 v45, v45, v19
    v_mul_f32 v46, v46, v19
    v_mul_f32 v47, v47, v19
    v_mul_f32 v48, v48, v19
    v_mul_f32 v49, v49, v19
    v_mul_f32 v50, v50, v19
    v_mul_f32 v51, v51, v19
    v_mul_f32 v52, v52, v19
    v_mul_f32 v53, v53, v19
    v_mul_f32 v54, v54, v19
    v_mul_f32 v55, v55, v19
    v_mul_f32 v56, v56, v19
    v_mul_f32 v57, v57, v19
    v_mul_f32 v58, v58, v19
    v_mul_f32 v59, v59, v19
    v_mul_f32 v60, v60, v19
    v_mul_f32 v61, v61, v19
    v_mul_f32 v62, v62, v19
    v_mul_f32 v63, v63, v19
    s_barrier
    s_lshr_b32 s38, s30, 2
    s_lshl_b32 s38, s38, 15
    s_lshl_b32 s39, s3, 11
    s_add_u32 s39, s39, s38
    v_add_u32 v3, s39, v16
    s_cmp_eq_u32 s3, 0
    s_cbranch_scc1 L_fused_own36
    ds_write_b128 v3, v[32:35] offset:0
    ds_write_b128 v3, v[36:39] offset:1024
    s_branch L_fused_nxt37
L_fused_own36:
    v_mov_b32 v64, v32
    v_mov_b32 v65, v33
    v_mov_b32 v66, v34
    v_mov_b32 v67, v35
    v_mov_b32 v68, v36
    v_mov_b32 v69, v37
    v_mov_b32 v70, v38
    v_mov_b32 v71, v39
L_fused_nxt37:
    s_cmp_eq_u32 s3, 1
    s_cbranch_scc1 L_fused_own38
    ds_write_b128 v3, v[40:43] offset:8192
    ds_write_b128 v3, v[44:47] offset:9216
    s_branch L_fused_nxt39
L_fused_own38:
    v_mov_b32 v64, v40
    v_mov_b32 v65, v41
    v_mov_b32 v66, v42
    v_mov_b32 v67, v43
    v_mov_b32 v68, v44
    v_mov_b32 v69, v45
    v_mov_b32 v70, v46
    v_mov_b32 v71, v47
L_fused_nxt39:
    s_cmp_eq_u32 s3, 2
    s_cbranch_scc1 L_fused_own40
    ds_write_b128 v3, v[48:51] offset:16384
    ds_write_b128 v3, v[52:55] offset:17408
    s_branch L_fused_nxt41
L_fused_own40:
    v_mov_b32 v64, v48
    v_mov_b32 v65, v49
    v_mov_b32 v66, v50
    v_mov_b32 v67, v51
    v_mov_b32 v68, v52
    v_mov_b32 v69, v53
    v_mov_b32 v70, v54
    v_mov_b32 v71, v55
L_fused_nxt41:
    s_cmp_eq_u32 s3, 3
    s_cbranch_scc1 L_fused_own42
    ds_write_b128 v3, v[56:59] offset:24576
    ds_write_b128 v3, v[60:63] offset:25600
    s_branch L_fused_nxt43
L_fused_own42:
    v_mov_b32 v64, v56
    v_mov_b32 v65, v57
    v_mov_b32 v66, v58
    v_mov_b32 v67, v59
    v_mov_b32 v68, v60
    v_mov_b32 v69, v61
    v_mov_b32 v70, v62
    v_mov_b32 v71, v63
L_fused_nxt43:
    s_lshl_b32 s39, s3, 13
    s_add_u32 s38, s38, s39
    s_add_u32 s39, s3, 1
    s_and_b32 s39, s39, 3
    s_lshl_b32 s39, s39, 11
    s_add_u32 s39, s39, s38
    v_add_u32 v4, s39, v16
    s_add_u32 s39, s3, 2
    s_and_b32 s39, s39, 3
    s_lshl_b32 s39, s39, 11
    s_add_u32 s39, s39, s38
    v_add_u32 v5, s39, v16
    s_add_u32 s39, s3, 3
    s_and_b32 s39, s39, 3
    s_lshl_b32 s39, s39, 11
    s_add_u32 s39, s39, s38
    v_add_u32 v6, s39, v16
    s_lshl_b32 s38, s40, 6
    s_lshr_b32 s39, s30, 2
    s_lshl_b32 s39, s39, 5
    s_add_u32 s38, s38, s39
    s_lshl_b32 s38, s38, 10
    s_lshl_b32 s39, s41, 7
    s_add_u32 s38, s38, s39
    s_lshl_b32 s39, s3, 5
    s_add_u32 s46, s38, s39
    v_and_b32 v3, 31, v2
    v_lshlrev_b32 v3, 10, v3
    v_lshrrev_b32 v7, 5, v2
    v_lshl_add_u32 v3, v7, 4, v3
    s_waitcnt lgkmcnt(0)
    s_barrier
    ds_read_b128 v[72:75], v4
    ds_read_b128 v[76:79], v4 offset:1024
    ds_read_b128 v[80:83], v5
    ds_read_b128 v[84:87], v5 offset:1024
    ds_read_b128 v[88:91], v6
    ds_read_b128 v[92:95], v6 offset:1024
    s_waitcnt lgkmcnt(4)
    v_add_f32 v64, v64, v72
    v_add_f32 v65, v65, v73
    v_add_f32 v66, v66, v74
    v_add_f32 v67, v67, v75
    v_add_f32 v68, v68, v76
    v_add_f32 v69, v69, v77
    v_add_f32 v70, v70, v78
    v_add_f32 v71, v71, v79
    s_waitcnt lgkmcnt(2)
    v_add_f32 v64, v64, v80
    v_add_f32 v65, v65, v81
    v_add_f32 v66, v66, v82
    v_add_f32 v67, v67, v83
    v_add_f32 v68, v68, v84
    v_add_f32 v69, v69, v85
    v_add_f32 v70, v70, v86
    v_add_f32 v71, v71, v87
    s_waitcnt lgkmcnt(0)
    v_add_f32 v64, v64, v88
    v_add_f32 v65, v65, v89
    v_add_f32 v66, v66, v90
    v_add_f32 v67, v67, v91
    v_add_f32 v68, v68, v92
    v_add_f32 v69, v69, v93
    v_add_f32 v70, v70, v94
    v_add_f32 v71, v71, v95
    v_cvt_pk_bf16_f32 v100, v64, v65
    v_cvt_pk_bf16_f32 v101, v66, v67
    v_cvt_pk_bf16_f32 v102, v68, v69
    v_cvt_pk_bf16_f32 v103, v70, v71
    s_nop 0
    v_permlane32_swap_b32 v100, v102
    v_permlane32_swap_b32 v101, v103
    buffer_store_dwordx4 v[100:103], v3, s[20:23], s46 offen
L_fused_end:
    s_endpgm
L_fused_codeend:

.section .rodata,"a"
.p2align 6
.amdhsa_kernel gated_mix__sliding_local_dilated__dense_activation_mish__prompt_kernel
  .amdhsa_next_free_vgpr 256
  .amdhsa_next_free_sgpr 102
  .amdhsa_accum_offset 256
  .amdhsa_group_segment_fixed_size 0
  .amdhsa_kernarg_size 88
  .amdhsa_user_sgpr_count 2
  .amdhsa_user_sgpr_kernarg_segment_ptr 1
  .amdhsa_system_sgpr_workgroup_id_x 1
.end_amdhsa_kernel
```
